```python
import torch

def _softmax(x, axis=-1):
    return torch.softmax(x, dim=axis)
def _gelu(x):
    return torch.nn.functional.gelu(x, approximate="tanh")
def _silu(x):
    return torch.nn.functional.silu(x)
def _sigmoid(x):
    return torch.sigmoid(x)
def _layernorm(x, axis=-1, eps=1e-5):
    m = x.mean(dim=axis, keepdim=True)
    v = x.var(dim=axis, keepdim=True, unbiased=False)
    return (x - m) / torch.sqrt(v + eps)
def _scatter_add(tgt, idx, src, axis=0):
    return tgt.clone().index_add_(axis, idx, src)
def _segment_sum(src, seg, n):
    out = torch.zeros((n,) + src.shape[1:], dtype=src.dtype)
    return out.index_add_(0, seg, src)
def _pad(x, pw):
    flat = tuple(v for pair in reversed(pw) for v in pair)
    return torch.nn.functional.pad(x, flat)

kernel_name = 'recurrent_scan__linear_kernel_hedgehog__dense_activation_gelu__prompt'

def setup_inputs():

    _w = (lambda a: (lambda t: t.to(torch.bfloat16) if t.is_floating_point() else t)(torch.as_tensor(a)))
    def _A_setup():
        B, S, D, H = 1, 2048, 1024, 32
        Dh = D // H
        return {
            "x": _w((lambda *s: torch.randn(*s, dtype=torch.bfloat16) * 0.05)(B, S, D)),
            "wqkv": _w((lambda *s: torch.randn(*s, dtype=torch.bfloat16) * 0.4)(D, 3 * D)),
            "w_phi": _w((lambda *s: torch.randn(*s, dtype=torch.bfloat16) * 0.4)(H, Dh, Dh) * (Dh ** -0.5)),
            "wo": _w((lambda *s: torch.randn(*s, dtype=torch.bfloat16) * 0.2)(D, D)),
        }
    _A_in = _A_setup()

    def _B_setup():
        B, S, D, F = 1, 2048, 1024, 3584
        return {
            "x": _w((lambda *s: torch.randn(*s, dtype=torch.bfloat16) * 0.05)(B, S, D)),
            "w1": _w((lambda *s: torch.randn(*s, dtype=torch.bfloat16) * 0.4)(D, F) * (D ** -0.5)),
            "b1": _w((lambda *s: torch.randn(*s, dtype=torch.bfloat16) * 12.8)(F) * 0.01),
            "w2": _w((lambda *s: torch.randn(*s, dtype=torch.bfloat16) * 0.1)(F, D) * (F ** -0.5)),
            "b2": _w((lambda *s: torch.randn(*s, dtype=torch.bfloat16) * 0.8)(D) * 0.01),
        }
    _B_in = _B_setup()

    return {
        "A_x": _A_in["x"],
        "A_wqkv": _A_in["wqkv"],
        "A_w_phi": _A_in["w_phi"],
        "A_wo": _A_in["wo"],
        "B_x": _B_in["x"],
        "B_w1": _B_in["w1"],
        "B_b1": _B_in["b1"],
        "B_w2": _B_in["w2"],
        "B_b2": _B_in["b2"],
    }

def reference(A_x, A_wqkv, A_w_phi, A_wo, B_x, B_w1, B_b1, B_w2, B_b2):
    def _A_ref(x, wqkv, w_phi, wo):
        B, S, D = x.shape
        H = 32; Dh = D // H
        qkv = (lambda x, *d: x.permute(*d))((x @ wqkv).reshape(B, S, 3, H, Dh), 2, 0, 3, 1, 4)
        q, k, v = qkv[0], qkv[1], qkv[2]
        pq = torch.einsum("bhsd,hdf->bhsf", q, w_phi)
        pk = torch.einsum("bhsd,hdf->bhsf", k, w_phi)
        phi_q = torch.concatenate([_softmax(pq, axis=-1), _softmax(-pq, axis=-1)], axis=-1)
        phi_k = torch.concatenate([_softmax(pk, axis=-1), _softmax(-pk, axis=-1)], axis=-1)
        kv = torch.einsum("bhsf,bhsd->bhfd", phi_k, v)
        z  = torch.einsum("bhsf->bhf", phi_k)
        num = torch.einsum("bhqf,bhfd->bhqd", phi_q, kv)
        den = torch.einsum("bhqf,bhf->bhq", phi_q, z)[..., None] + 1e-6
        o = num / den
        return (lambda x, *d: x.permute(*d))(o, 0, 2, 1, 3).reshape(B, S, D) @ wo

    def _B_ref(x, w1, b1, w2, b2):
        h = torch.einsum("bsd,df->bsf", x, w1) + b1
        h = _gelu(h)
        return torch.einsum("bsf,fd->bsd", h, w2) + b2

    x = A_x
    xn = _layernorm(x, axis=-1)
    s = _A_ref(xn, A_wqkv, A_w_phi, A_wo)
    g = _silu(_B_ref(xn, B_w1, B_b1, B_w2, B_b2))
    return x + s * g
```

```asm
; @launch kernel=ln_kernel grid=(512,1,1) block=(256,1,1) lds=0
; @launch kernel=mid_kernel grid=(256,1,1) block=(512,1,1) lds=163840
.amdgcn_target "amdgcn-amd-amdhsa--gfx950"
.text
.globl ln_kernel
.p2align 8
.type ln_kernel,@function
ln_kernel:
    s_cmp_ge_u32 s2, 512
    s_cbranch_scc1 .Lk1_end
    s_load_dwordx2 s[4:5], s[0:1], 0
    s_load_dwordx2 s[8:9], s[0:1], 88
    v_lshrrev_b32 v1, 6, v0
    v_and_b32 v2, 63, v0
    s_lshl_b32 s3, s2, 2
    v_add_u32 v1, s3, v1
    v_lshlrev_b32 v1, 11, v1
    v_lshl_add_u32 v1, v2, 4, v1
    s_mov_b32 s6, 0x00400000
    s_mov_b32 s7, 0x00020000
    s_mov_b32 s10, 0x10000000
    s_mov_b32 s11, 0x00020000
    s_mov_b32 s12, 0xffff0000
    s_waitcnt lgkmcnt(0)
    buffer_load_dwordx4 v[4:7], v1, s[4:7], 0 offen
    buffer_load_dwordx4 v[8:11], v1, s[4:7], 0 offen offset:1024
    v_lshrrev_b32 v2, 6, v0
    s_nop 0
    v_readfirstlane_b32 s3, v2
    v_and_b32 v38, 63, v0
    s_and_b32 s44, s2, 8
    s_lshr_b32 s44, s44, 1
    s_add_u32 s44, s44, s3
    s_getpc_b64 s[40:41]
.Lpc_k1:
    s_add_u32 s40, s40, .Lmid0-.Lpc_k1
    s_addc_u32 s41, s41, 0
    v_lshlrev_b32 v34, 6, v38
    v_lshl_add_u32 v34, s44, 12, v34
    v_min_u32 v34, .Lk4_end-.Lmid0, v34
    v_mov_b32 v35, s41
    v_add_co_u32 v34, vcc, s40, v34
    s_nop 1
    v_addc_co_u32 v35, vcc, 0, v35, vcc
    global_load_dword v38, v[34:35], off
    s_lshl_b32 s13, s2, 2
    s_add_u32 s13, s13, s3
    v_and_b32 v2, 63, v0
    v_lshlrev_b32 v2, 6, v2
    s_load_dwordx2 s[24:25], s[0:1], 8
    s_mov_b32 s26, 0x00600000
    s_mov_b32 s27, 0x00020000
    s_mul_i32 s14, s13, 384
    v_cmp_gt_u32 vcc, 384, v2
    s_waitcnt lgkmcnt(0)
    s_and_saveexec_b64 s[16:17], vcc
    buffer_load_dword v36, v2, s[24:27], s14 offen
    s_mov_b64 exec, s[16:17]
    s_load_dwordx2 s[28:29], s[0:1], 40
    s_mov_b32 s30, 0x00700000
    s_mov_b32 s31, 0x00020000
    s_mul_i32 s14, s13, 448
    v_cmp_gt_u32 vcc, 448, v2
    s_waitcnt lgkmcnt(0)
    s_and_saveexec_b64 s[16:17], vcc
    buffer_load_dword v37, v2, s[28:31], s14 offen
    s_mov_b64 exec, s[16:17]
    s_waitcnt vmcnt(3)
    v_lshlrev_b32 v12, 16, v4
    v_and_b32 v13, s12, v4
    v_lshlrev_b32 v14, 16, v5
    v_and_b32 v15, s12, v5
    v_lshlrev_b32 v16, 16, v6
    v_and_b32 v17, s12, v6
    v_lshlrev_b32 v18, 16, v7
    v_and_b32 v19, s12, v7
    v_lshlrev_b32 v20, 16, v8
    v_and_b32 v21, s12, v8
    v_lshlrev_b32 v22, 16, v9
    v_and_b32 v23, s12, v9
    v_lshlrev_b32 v24, 16, v10
    v_and_b32 v25, s12, v10
    v_lshlrev_b32 v26, 16, v11
    v_and_b32 v27, s12, v11
    v_add_f32 v28, v12, v13
    v_add_f32 v29, v14, v15
    v_add_f32 v30, v16, v17
    v_add_f32 v31, v18, v19
    v_add_f32 v32, v20, v21
    v_add_f32 v33, v22, v23
    v_add_f32 v34, v24, v25
    v_add_f32 v35, v26, v27
    v_add_f32 v28, v28, v32
    v_add_f32 v29, v29, v33
    v_add_f32 v30, v30, v34
    v_add_f32 v31, v31, v35
    v_add_f32 v28, v28, v30
    v_add_f32 v29, v29, v31
    v_add_f32 v28, v28, v29
    s_nop 1
    v_add_f32_dpp v28, v28, v28 quad_perm:[1,0,3,2] row_mask:0xf bank_mask:0xf
    s_nop 1
    v_add_f32_dpp v28, v28, v28 quad_perm:[2,3,0,1] row_mask:0xf bank_mask:0xf
    s_nop 1
    v_add_f32_dpp v28, v28, v28 row_half_mirror row_mask:0xf bank_mask:0xf
    s_nop 1
    v_add_f32_dpp v28, v28, v28 row_mirror row_mask:0xf bank_mask:0xf
    v_mov_b32 v29, v28
    s_nop 1
    v_permlane16_swap_b32 v28, v29
    s_nop 1
    v_add_f32 v28, v28, v29
    v_mov_b32 v29, v28
    s_nop 1
    v_permlane32_swap_b32 v28, v29
    s_nop 1
    v_add_f32 v28, v28, v29
    v_mul_f32 v28, 0x3a800000, v28
    v_sub_f32 v12, v12, v28
    v_sub_f32 v13, v13, v28
    v_sub_f32 v14, v14, v28
    v_sub_f32 v15, v15, v28
    v_sub_f32 v16, v16, v28
    v_sub_f32 v17, v17, v28
    v_sub_f32 v18, v18, v28
    v_sub_f32 v19, v19, v28
    v_sub_f32 v20, v20, v28
    v_sub_f32 v21, v21, v28
    v_sub_f32 v22, v22, v28
    v_sub_f32 v23, v23, v28
    v_sub_f32 v24, v24, v28
    v_sub_f32 v25, v25, v28
    v_sub_f32 v26, v26, v28
    v_sub_f32 v27, v27, v28
    v_mul_f32 v30, v12, v12
    v_mul_f32 v31, v13, v13
    v_mul_f32 v32, v14, v14
    v_mul_f32 v33, v15, v15
    v_fmac_f32 v30, v16, v16
    v_fmac_f32 v31, v17, v17
    v_fmac_f32 v32, v18, v18
    v_fmac_f32 v33, v19, v19
    v_fmac_f32 v30, v20, v20
    v_fmac_f32 v31, v21, v21
    v_fmac_f32 v32, v22, v22
    v_fmac_f32 v33, v23, v23
    v_fmac_f32 v30, v24, v24
    v_fmac_f32 v31, v25, v25
    v_fmac_f32 v32, v26, v26
    v_fmac_f32 v33, v27, v27
    v_add_f32 v30, v30, v32
    v_add_f32 v31, v31, v33
    v_add_f32 v30, v30, v31
    s_nop 1
    v_add_f32_dpp v30, v30, v30 quad_perm:[1,0,3,2] row_mask:0xf bank_mask:0xf
    s_nop 1
    v_add_f32_dpp v30, v30, v30 quad_perm:[2,3,0,1] row_mask:0xf bank_mask:0xf
    s_nop 1
    v_add_f32_dpp v30, v30, v30 row_half_mirror row_mask:0xf bank_mask:0xf
    s_nop 1
    v_add_f32_dpp v30, v30, v30 row_mirror row_mask:0xf bank_mask:0xf
    v_mov_b32 v31, v30
    s_nop 1
    v_permlane16_swap_b32 v30, v31
    s_nop 1
    v_add_f32 v30, v30, v31
    v_mov_b32 v31, v30
    s_nop 1
    v_permlane32_swap_b32 v30, v31
    s_nop 1
    v_add_f32 v30, v30, v31
    v_mov_b32 v31, 0x3727c5ac
    v_fmac_f32 v31, 0x3a800000, v30
    v_rsq_f32 v31, v31
    s_nop 0
    v_mul_f32 v12, v12, v31
    v_mul_f32 v13, v13, v31
    v_mul_f32 v14, v14, v31
    v_mul_f32 v15, v15, v31
    v_mul_f32 v16, v16, v31
    v_mul_f32 v17, v17, v31
    v_mul_f32 v18, v18, v31
    v_mul_f32 v19, v19, v31
    v_mul_f32 v20, v20, v31
    v_mul_f32 v21, v21, v31
    v_mul_f32 v22, v22, v31
    v_mul_f32 v23, v23, v31
    v_mul_f32 v24, v24, v31
    v_mul_f32 v25, v25, v31
    v_mul_f32 v26, v26, v31
    v_mul_f32 v27, v27, v31
    v_cvt_pk_bf16_f32 v4, v12, v13
    v_cvt_pk_bf16_f32 v5, v14, v15
    v_cvt_pk_bf16_f32 v6, v16, v17
    v_cvt_pk_bf16_f32 v7, v18, v19
    v_cvt_pk_bf16_f32 v8, v20, v21
    v_cvt_pk_bf16_f32 v9, v22, v23
    v_cvt_pk_bf16_f32 v10, v24, v25
    v_cvt_pk_bf16_f32 v11, v26, v27
    buffer_store_dwordx4 v[4:7], v1, s[8:11], 0 offen
    buffer_store_dwordx4 v[8:11], v1, s[8:11], 0 offen offset:1024
    s_cmp_ge_u32 s2, 296
    s_cbranch_scc1 .Lk1_noflag
    s_cmp_lg_u32 s3, 0
    s_cbranch_scc1 .Lk1_noflag
    v_lshlrev_b32 v2, 2, v0
    s_mov_b64 exec, 15
    s_lshl_b32 s13, s2, 7
    s_add_u32 s13, s13, 0x03000000
    v_mov_b32 v3, 0
    buffer_store_dword v3, v2, s[8:11], s13 offen
    s_mov_b64 exec, -1
.Lk1_noflag:
    s_waitcnt vmcnt(0)
    s_waitcnt vmcnt(0)
.Lk1_end:
s_endpgm
.globl mid_kernel
.p2align 8
.type mid_kernel,@function
mid_kernel:
.Lmid0:
    s_cmp_ge_u32 s2, 256
    s_cbranch_scc1 .Lk4_end
    s_load_dwordx2 s[4:5], s[0:1], 88
    s_load_dwordx2 s[12:13], s[0:1], 88
    v_lshrrev_b32 v1, 6, v0
    v_and_b32 v240, 63, v0
    v_readfirstlane_b32 s3, v1
    s_mov_b32 s14, 0x10000000
    s_mov_b32 s15, 0x00020000
    s_and_b32 s36, s2, 7
    s_lshr_b32 s37, s2, 3
    s_and_b32 s20, s37, 7
    s_lshr_b32 s37, s37, 3
    s_lshr_b32 s21, s36, 1
    s_lshl_b32 s21, s21, 2
    s_add_u32 s21, s21, s37
    s_and_b32 s39, s36, 1
    s_and_b32 s22, s3, 3
    s_lshr_b32 s23, s3, 2
    s_mov_b32 s24, 0
    s_mov_b32 s25, 32768
    s_mov_b32 s26, 65536
    s_lshl_b32 s28, s20, 19
    s_mov_b32 s30, 0
    s_lshl_b32 s31, s3, 11
    s_mov_b32 s34, 0x10000000
    s_mov_b32 s6, 0x00400000
    s_mov_b32 s7, 0x00020000
    v_lshrrev_b32 v241, 3, v240
    s_lshl_b32 s36, s3, 4
    v_add_u32 v241, s36, v241
    v_lshlrev_b32 v241, 11, v241
    v_and_b32 v242, 7, v240
    v_lshrrev_b32 v243, 4, v240
    v_xor_b32 v242, v242, v243
    v_lshl_add_u32 v236, v242, 4, v241
    v_xor_b32 v237, 64, v236
    v_add_u32 v237, 15360, v237
    s_cmp_eq_u32 s39, 0
    s_cbranch_scc1 .Lk2_att
    s_load_dwordx2 s[8:9], s[0:1], 40
    s_load_dwordx2 s[16:17], s[0:1], 48
    s_mov_b32 s10, 0x00700000
    s_mov_b32 s11, 0x00020000
    s_mov_b32 s18, 7168
    s_mov_b32 s19, 0x00020000
    s_mov_b32 s40, -1
    s_mov_b32 s41, 0x00ffffff
    s_load_dwordx2 s[64:65], s[0:1], 40
    s_load_dwordx2 s[68:69], s[0:1], 56
    s_mov_b32 s66, 0x00700000
    s_mov_b32 s67, 0x00020000
    s_mov_b32 s70, 0x00700000
    s_mov_b32 s71, 0x00020000
    s_mov_b32 s72, 0x000e0000
    s_mov_b32 s73, 0x00070000
    s_mov_b32 s74, 0x00070000
    s_lshl_b32 s36, s20, 3
    s_add_u32 s36, s36, s3
    s_lshl_b32 s37, s21, 6
    s_add_u32 s37, s37, s36
    s_mul_i32 s37, s37, 448
    s_mul_i32 s36, s36, 7168
    s_mul_i32 s38, s21, 448
    s_add_u32 s36, s36, s38
    v_lshlrev_b32 v241, 6, v240
    v_add_u32 v254, s37, v241
    v_add_u32 v253, s36, v241
    v_mov_b32 v241, s34
    v_cmp_gt_u32 vcc, 7, v240
    s_nop 1
    v_cndmask_b32 v253, v241, v253, vcc
    v_cndmask_b32 v254, v241, v254, vcc
    v_cmp_le_u32 vcc, 28, v240
    s_nop 1
    v_cndmask_b32 v241, 0, 1, vcc
    v_mul_u32_u24 v242, 28, v241
    v_sub_u32 v242, v240, v242
    v_lshrrev_b32 v243, 1, v242
    v_and_b32 v242, 1, v242
    v_add_u32 v244, -1, v243
    v_cmp_gt_u32 vcc, 6, v243
    s_nop 1
    v_cndmask_b32 v244, v244, v243, vcc
    v_cmp_eq_u32 vcc, 6, v243
    s_nop 1
    v_cndmask_b32 v244, v244, 12, vcc
    v_cmp_le_u32 vcc, 13, v243
    s_nop 1
    v_cndmask_b32 v244, v244, 13, vcc
    v_lshlrev_b32 v244, 5, v244
    v_lshl_add_u32 v244, v242, 4, v244
    s_lshl_b32 s36, s3, 2
    v_add_u32 v241, s36, v241
    v_mul_u32_u24 v241, 7168, v241
    v_add_u32 v241, v241, v244
    s_mul_i32 s36, s21, 448
    v_add_u32 v238, s36, v241
    v_add_u32 v239, 13440, v238
    s_mul_i32 s32, s3, 1792
    s_lshr_b32 s36, s3, 1
    s_lshl_b32 s36, s36, 5
    s_add_u32 s32, s32, s36
    s_add_u32 s32, s32, 98304
    v_and_b32 v241, 15, v240
    v_lshrrev_b32 v242, 1, v241
    v_lshrrev_b32 v243, 4, v240
    v_xor_b32 v242, v242, v243
    s_lshl_b32 s36, s22, 6
    v_add_u32 v241, s36, v241
    v_lshlrev_b32 v241, 7, v241
    v_lshl_add_u32 v202, v242, 4, v241
    v_xor_b32 v203, 64, v202
    v_mov_b32 v200, v202
    v_mov_b32 v201, v203
    v_bfe_u32 v241, v240, 2, 2
    v_lshl_add_u32 v241, v243, 3, v241
    v_mul_u32_u24 v241, 448, v241
    v_lshl_add_u32 v241, v243, 5, v241
    v_and_b32 v242, 3, v240
    v_lshl_add_u32 v241, v242, 3, v241
    s_mul_i32 s36, s23, 224
    s_add_u32 s36, s36, 98304
    v_add_u32 v205, s36, v241
    v_mov_b32 v204, v205
    s_mul_i32 s36, s21, 448
    s_mul_i32 s37, s23, 192
    s_add_u32 s37, s37, s36
    s_lshl_b32 s38, s23, 5
    s_add_u32 s38, s38, s36
    v_lshlrev_b32 v241, 3, v243
    s_waitcnt lgkmcnt(0)
    buffer_load_dwordx2 v[206:207], v241, s[16:19], s37 offen offset:0
    buffer_load_dwordx2 v[208:209], v241, s[16:19], s37 offen offset:32
    buffer_load_dwordx2 v[210:211], v241, s[16:19], s37 offen offset:64
    buffer_load_dwordx2 v[212:213], v241, s[16:19], s37 offen offset:96
    buffer_load_dwordx2 v[214:215], v241, s[16:19], s37 offen offset:128
    buffer_load_dwordx2 v[216:217], v241, s[16:19], s37 offen offset:160
    buffer_load_dwordx2 v[218:219], v241, s[16:19], s38 offen offset:384
    s_mov_b32 s29, 0
    s_mov_b32 s27, 0
    s_add_u32 s36, s29, 0
    s_cmp_lt_u32 s36, 2048
    s_cselect_b32 s37, s28, s34
    s_add_u32 s36, s36, s37
    s_add_u32 s37, s24, s31
    s_add_u32 m0, s37, 0
    s_nop 0
    buffer_load_dwordx4 v236, s[4:7], s36 offen lds
    buffer_load_dwordx4 v237, s[4:7], s36 offen offset:1024 lds
    s_add_u32 s36, s29, 0
    s_cmp_lt_u32 s36, 2048
    s_cselect_b32 s37, s28, s34
    s_add_u32 s36, s36, s37
    s_add_u32 s36, s36, 262144
    s_add_u32 s37, s24, s31
    s_add_u32 m0, s37, 16384
    s_nop 0
    buffer_load_dwordx4 v236, s[4:7], s36 offen lds
    buffer_load_dwordx4 v237, s[4:7], s36 offen offset:1024 lds
    s_add_u32 s37, s32, s27
    s_add_u32 m0, s37, 0
    s_mov_b64 exec, s[40:41]
    buffer_load_dwordx4 v238, s[8:11], s30 offen lds
    buffer_load_dwordx4 v239, s[8:11], s30 offen offset:896 lds
    buffer_load_dword v255, v253, s[64:67], s34 offen
    s_mov_b64 exec, -1
    s_add_u32 s30, s30, 229376
    s_add_u32 s36, s29, 128
    s_cmp_lt_u32 s36, 2048
    s_cselect_b32 s37, s28, s34
    s_add_u32 s36, s36, s37
    s_add_u32 s37, s25, s31
    s_add_u32 m0, s37, 0
    s_nop 0
    buffer_load_dwordx4 v236, s[4:7], s36 offen lds
    buffer_load_dwordx4 v237, s[4:7], s36 offen offset:1024 lds
    s_add_u32 s37, s32, s27
    s_add_u32 m0, s37, 14464
    s_mov_b64 exec, s[40:41]
    buffer_load_dwordx4 v238, s[8:11], s30 offen lds
    buffer_load_dwordx4 v239, s[8:11], s30 offen offset:896 lds
    buffer_load_dword v255, v253, s[64:67], s34 offen
    s_mov_b64 exec, -1
    s_add_u32 s30, s30, 229376
    s_add_u32 s36, s29, 128
    s_cmp_lt_u32 s36, 2048
    s_cselect_b32 s37, s28, s34
    s_add_u32 s36, s36, s37
    s_add_u32 s36, s36, 262144
    s_add_u32 s37, s25, s31
    s_add_u32 m0, s37, 16384
    s_nop 0
    buffer_load_dwordx4 v236, s[4:7], s36 offen lds
    buffer_load_dwordx4 v237, s[4:7], s36 offen offset:1024 lds
    s_add_u32 s37, s32, s27
    s_add_u32 m0, s37, 28928
    s_mov_b64 exec, s[40:41]
    buffer_load_dwordx4 v238, s[8:11], s30 offen lds
    buffer_load_dwordx4 v239, s[8:11], s30 offen offset:896 lds
    buffer_load_dword v255, v253, s[64:67], s72 offen
    s_add_u32 s72, s72, s73
    s_mov_b64 exec, -1
    s_add_u32 s30, s30, 229376
    s_add_u32 s36, s29, 256
    s_cmp_lt_u32 s36, 2048
    s_cselect_b32 s37, s28, s34
    s_add_u32 s36, s36, s37
    s_add_u32 s37, s26, s31
    s_add_u32 m0, s37, 0
    s_nop 0
    buffer_load_dwordx4 v236, s[4:7], s36 offen lds
    buffer_load_dwordx4 v237, s[4:7], s36 offen offset:1024 lds
    s_add_u32 s37, s32, s27
    s_add_u32 m0, s37, 43392
    s_mov_b64 exec, s[40:41]
    buffer_load_dwordx4 v238, s[8:11], s30 offen lds
    buffer_load_dwordx4 v239, s[8:11], s30 offen offset:896 lds
    buffer_load_dword v255, v253, s[64:67], s72 offen
    s_add_u32 s72, s72, s73
    s_mov_b64 exec, -1
    s_add_u32 s30, s30, 229376
    s_mov_b32 s29, 256
    s_waitcnt vmcnt(22)
    s_mov_b32 s36, 0xffff0000
    v_lshlrev_b32 v0, 16, v206
    v_and_b32 v1, s36, v206
    v_lshlrev_b32 v2, 16, v207
    v_and_b32 v3, s36, v207
    v_mov_b32 v4, v0
    v_mov_b32 v5, v1
    v_mov_b32 v6, v2
    v_mov_b32 v7, v3
    v_mov_b32 v8, v0
    v_mov_b32 v9, v1
    v_mov_b32 v10, v2
    v_mov_b32 v11, v3
    v_mov_b32 v12, v0
    v_mov_b32 v13, v1
    v_mov_b32 v14, v2
    v_mov_b32 v15, v3
    v_lshlrev_b32 v16, 16, v208
    v_and_b32 v17, s36, v208
    v_lshlrev_b32 v18, 16, v209
    v_and_b32 v19, s36, v209
    v_mov_b32 v20, v16
    v_mov_b32 v21, v17
    v_mov_b32 v22, v18
    v_mov_b32 v23, v19
    v_mov_b32 v24, v16
    v_mov_b32 v25, v17
    v_mov_b32 v26, v18
    v_mov_b32 v27, v19
    v_mov_b32 v28, v16
    v_mov_b32 v29, v17
    v_mov_b32 v30, v18
    v_mov_b32 v31, v19
    v_lshlrev_b32 v32, 16, v210
    v_and_b32 v33, s36, v210
    v_lshlrev_b32 v34, 16, v211
    v_and_b32 v35, s36, v211
    v_mov_b32 v36, v32
    v_mov_b32 v37, v33
    v_mov_b32 v38, v34
    v_mov_b32 v39, v35
    v_mov_b32 v40, v32
    v_mov_b32 v41, v33
    v_mov_b32 v42, v34
    v_mov_b32 v43, v35
    v_mov_b32 v44, v32
    v_mov_b32 v45, v33
    v_mov_b32 v46, v34
    v_mov_b32 v47, v35
    v_lshlrev_b32 v48, 16, v212
    v_and_b32 v49, s36, v212
    v_lshlrev_b32 v50, 16, v213
    v_and_b32 v51, s36, v213
    v_mov_b32 v52, v48
    v_mov_b32 v53, v49
    v_mov_b32 v54, v50
    v_mov_b32 v55, v51
    v_mov_b32 v56, v48
    v_mov_b32 v57, v49
    v_mov_b32 v58, v50
    v_mov_b32 v59, v51
    v_mov_b32 v60, v48
    v_mov_b32 v61, v49
    v_mov_b32 v62, v50
    v_mov_b32 v63, v51
    v_lshlrev_b32 v64, 16, v214
    v_and_b32 v65, s36, v214
    v_lshlrev_b32 v66, 16, v215
    v_and_b32 v67, s36, v215
    v_mov_b32 v68, v64
    v_mov_b32 v69, v65
    v_mov_b32 v70, v66
    v_mov_b32 v71, v67
    v_mov_b32 v72, v64
    v_mov_b32 v73, v65
    v_mov_b32 v74, v66
    v_mov_b32 v75, v67
    v_mov_b32 v76, v64
    v_mov_b32 v77, v65
    v_mov_b32 v78, v66
    v_mov_b32 v79, v67
    v_lshlrev_b32 v80, 16, v216
    v_and_b32 v81, s36, v216
    v_lshlrev_b32 v82, 16, v217
    v_and_b32 v83, s36, v217
    v_mov_b32 v84, v80
    v_mov_b32 v85, v81
    v_mov_b32 v86, v82
    v_mov_b32 v87, v83
    v_mov_b32 v88, v80
    v_mov_b32 v89, v81
    v_mov_b32 v90, v82
    v_mov_b32 v91, v83
    v_mov_b32 v92, v80
    v_mov_b32 v93, v81
    v_mov_b32 v94, v82
    v_mov_b32 v95, v83
    v_lshlrev_b32 v96, 16, v218
    v_and_b32 v97, s36, v218
    v_lshlrev_b32 v98, 16, v219
    v_and_b32 v99, s36, v219
    v_mov_b32 v100, v96
    v_mov_b32 v101, v97
    v_mov_b32 v102, v98
    v_mov_b32 v103, v99
    v_mov_b32 v104, v96
    v_mov_b32 v105, v97
    v_mov_b32 v106, v98
    v_mov_b32 v107, v99
    v_mov_b32 v108, v96
    v_mov_b32 v109, v97
    v_mov_b32 v110, v98
    v_mov_b32 v111, v99
    s_waitcnt vmcnt(15)
    s_barrier
    ds_read_b64_tr_b16 v[128:129], v204 offset:0
    ds_read_b64_tr_b16 v[130:131], v204 offset:1792
    ds_read_b128 v[112:115], v200 offset:0
    ds_read_b128 v[116:119], v200 offset:2048
    ds_read_b128 v[120:123], v200 offset:4096
    ds_read_b128 v[124:127], v200 offset:6144
    ds_read_b64_tr_b16 v[132:133], v204 offset:32
    ds_read_b64_tr_b16 v[134:135], v204 offset:1824
    ds_read_b64_tr_b16 v[136:137], v204 offset:64
    ds_read_b64_tr_b16 v[138:139], v204 offset:1856
    ds_read_b64_tr_b16 v[140:141], v204 offset:96
    ds_read_b64_tr_b16 v[142:143], v204 offset:1888
    ds_read_b64_tr_b16 v[144:145], v204 offset:128
    ds_read_b64_tr_b16 v[146:147], v204 offset:1920
    ds_read_b64_tr_b16 v[148:149], v204 offset:160
    ds_read_b64_tr_b16 v[150:151], v204 offset:1952
    ds_read_b64_tr_b16 v[152:153], v204 offset:192
    ds_read_b64_tr_b16 v[154:155], v204 offset:1984
    s_mov_b32 s33, 16
.Lk2_mlp_loop:
    s_waitcnt lgkmcnt(0)
    v_mfma_f32_16x16x32_bf16 v[0:3], v[128:131], v[112:115], v[0:3]
    v_mfma_f32_16x16x32_bf16 v[4:7], v[128:131], v[116:119], v[4:7]
    v_mfma_f32_16x16x32_bf16 v[8:11], v[128:131], v[120:123], v[8:11]
    v_mfma_f32_16x16x32_bf16 v[12:15], v[128:131], v[124:127], v[12:15]
    s_waitcnt vmcnt(10)
    s_barrier
    ds_read_b64_tr_b16 v[172:173], v204 offset:14464
    v_mfma_f32_16x16x32_bf16 v[16:19], v[132:135], v[112:115], v[16:19]
    ds_read_b64_tr_b16 v[174:175], v204 offset:16256
    v_mfma_f32_16x16x32_bf16 v[20:23], v[132:135], v[116:119], v[20:23]
    ds_read_b128 v[156:159], v201 offset:0
    v_mfma_f32_16x16x32_bf16 v[24:27], v[132:135], v[120:123], v[24:27]
    ds_read_b128 v[160:163], v201 offset:2048
    v_mfma_f32_16x16x32_bf16 v[28:31], v[132:135], v[124:127], v[28:31]
    ds_read_b128 v[164:167], v201 offset:4096
    v_mfma_f32_16x16x32_bf16 v[32:35], v[136:139], v[112:115], v[32:35]
    ds_read_b128 v[168:171], v201 offset:6144
    v_mfma_f32_16x16x32_bf16 v[36:39], v[136:139], v[116:119], v[36:39]
    ds_read_b64_tr_b16 v[176:177], v204 offset:14496
    v_mfma_f32_16x16x32_bf16 v[40:43], v[136:139], v[120:123], v[40:43]
    ds_read_b64_tr_b16 v[178:179], v204 offset:16288
    v_mfma_f32_16x16x32_bf16 v[44:47], v[136:139], v[124:127], v[44:47]
    ds_read_b64_tr_b16 v[180:181], v204 offset:14528
    v_mfma_f32_16x16x32_bf16 v[48:51], v[140:143], v[112:115], v[48:51]
    ds_read_b64_tr_b16 v[182:183], v204 offset:16320
    v_mfma_f32_16x16x32_bf16 v[52:55], v[140:143], v[116:119], v[52:55]
    ds_read_b64_tr_b16 v[184:185], v204 offset:14560
    v_mfma_f32_16x16x32_bf16 v[56:59], v[140:143], v[120:123], v[56:59]
    ds_read_b64_tr_b16 v[186:187], v204 offset:16352
    v_mfma_f32_16x16x32_bf16 v[60:63], v[140:143], v[124:127], v[60:63]
    ds_read_b64_tr_b16 v[188:189], v204 offset:14592
    v_mfma_f32_16x16x32_bf16 v[64:67], v[144:147], v[112:115], v[64:67]
    ds_read_b64_tr_b16 v[190:191], v204 offset:16384
    v_mfma_f32_16x16x32_bf16 v[68:71], v[144:147], v[116:119], v[68:71]
    ds_read_b64_tr_b16 v[192:193], v204 offset:14624
    v_mfma_f32_16x16x32_bf16 v[72:75], v[144:147], v[120:123], v[72:75]
    ds_read_b64_tr_b16 v[194:195], v204 offset:16416
    v_mfma_f32_16x16x32_bf16 v[76:79], v[144:147], v[124:127], v[76:79]
    ds_read_b64_tr_b16 v[196:197], v204 offset:14656
    v_mfma_f32_16x16x32_bf16 v[80:83], v[148:151], v[112:115], v[80:83]
    ds_read_b64_tr_b16 v[198:199], v204 offset:16448
    v_mfma_f32_16x16x32_bf16 v[84:87], v[148:151], v[116:119], v[84:87]
    v_mfma_f32_16x16x32_bf16 v[88:91], v[148:151], v[120:123], v[88:91]
    s_add_u32 s36, s29, 0
    s_cmp_lt_u32 s36, 2048
    s_cselect_b32 s37, s28, s34
    s_add_u32 s36, s36, s37
    s_add_u32 s36, s36, 262144
    s_add_u32 s37, s26, s31
    s_add_u32 m0, s37, 16384
    s_nop 0
    buffer_load_dwordx4 v236, s[4:7], s36 offen lds
    v_mfma_f32_16x16x32_bf16 v[92:95], v[148:151], v[124:127], v[92:95]
    v_mfma_f32_16x16x32_bf16 v[96:99], v[152:155], v[112:115], v[96:99]
    buffer_load_dwordx4 v237, s[4:7], s36 offen offset:1024 lds
    v_mfma_f32_16x16x32_bf16 v[100:103], v[152:155], v[116:119], v[100:103]
    v_mfma_f32_16x16x32_bf16 v[104:107], v[152:155], v[120:123], v[104:107]
    s_add_u32 s37, s32, s27
    s_add_u32 m0, s37, 0
    s_mov_b64 exec, s[40:41]
    buffer_load_dwordx4 v238, s[8:11], s30 offen lds
    buffer_load_dwordx4 v239, s[8:11], s30 offen offset:896 lds
    buffer_load_dword v255, v253, s[64:67], s72 offen
    s_add_u32 s72, s72, s73
    s_mov_b64 exec, -1
    s_add_u32 s30, s30, 229376
    v_mfma_f32_16x16x32_bf16 v[108:111], v[152:155], v[124:127], v[108:111]
    s_waitcnt lgkmcnt(0)
    v_mfma_f32_16x16x32_bf16 v[0:3], v[172:175], v[156:159], v[0:3]
    v_mfma_f32_16x16x32_bf16 v[4:7], v[172:175], v[160:163], v[4:7]
    v_mfma_f32_16x16x32_bf16 v[8:11], v[172:175], v[164:167], v[8:11]
    v_mfma_f32_16x16x32_bf16 v[12:15], v[172:175], v[168:171], v[12:15]
    s_xor_b32 s38, s27, 28928
    v_add_u32 v200, s25, v202
    v_add_u32 v201, s25, v203
    v_add_u32 v204, s38, v205
    s_waitcnt vmcnt(10)
    s_barrier
    ds_read_b64_tr_b16 v[128:129], v204 offset:0
    v_mfma_f32_16x16x32_bf16 v[16:19], v[176:179], v[156:159], v[16:19]
    ds_read_b64_tr_b16 v[130:131], v204 offset:1792
    v_mfma_f32_16x16x32_bf16 v[20:23], v[176:179], v[160:163], v[20:23]
    ds_read_b128 v[112:115], v200 offset:0
    v_mfma_f32_16x16x32_bf16 v[24:27], v[176:179], v[164:167], v[24:27]
    ds_read_b128 v[116:119], v200 offset:2048
    v_mfma_f32_16x16x32_bf16 v[28:31], v[176:179], v[168:171], v[28:31]
    ds_read_b128 v[120:123], v200 offset:4096
    v_mfma_f32_16x16x32_bf16 v[32:35], v[180:183], v[156:159], v[32:35]
    ds_read_b128 v[124:127], v200 offset:6144
    v_mfma_f32_16x16x32_bf16 v[36:39], v[180:183], v[160:163], v[36:39]
    ds_read_b64_tr_b16 v[132:133], v204 offset:32
    v_mfma_f32_16x16x32_bf16 v[40:43], v[180:183], v[164:167], v[40:43]
    ds_read_b64_tr_b16 v[134:135], v204 offset:1824
    v_mfma_f32_16x16x32_bf16 v[44:47], v[180:183], v[168:171], v[44:47]
    ds_read_b64_tr_b16 v[136:137], v204 offset:64
    v_mfma_f32_16x16x32_bf16 v[48:51], v[184:187], v[156:159], v[48:51]
    ds_read_b64_tr_b16 v[138:139], v204 offset:1856
    v_mfma_f32_16x16x32_bf16 v[52:55], v[184:187], v[160:163], v[52:55]
    ds_read_b64_tr_b16 v[140:141], v204 offset:96
    v_mfma_f32_16x16x32_bf16 v[56:59], v[184:187], v[164:167], v[56:59]
    ds_read_b64_tr_b16 v[142:143], v204 offset:1888
    v_mfma_f32_16x16x32_bf16 v[60:63], v[184:187], v[168:171], v[60:63]
    ds_read_b64_tr_b16 v[144:145], v204 offset:128
    v_mfma_f32_16x16x32_bf16 v[64:67], v[188:191], v[156:159], v[64:67]
    ds_read_b64_tr_b16 v[146:147], v204 offset:1920
    v_mfma_f32_16x16x32_bf16 v[68:71], v[188:191], v[160:163], v[68:71]
    ds_read_b64_tr_b16 v[148:149], v204 offset:160
    v_mfma_f32_16x16x32_bf16 v[72:75], v[188:191], v[164:167], v[72:75]
    ds_read_b64_tr_b16 v[150:151], v204 offset:1952
    v_mfma_f32_16x16x32_bf16 v[76:79], v[188:191], v[168:171], v[76:79]
    ds_read_b64_tr_b16 v[152:153], v204 offset:192
    v_mfma_f32_16x16x32_bf16 v[80:83], v[192:195], v[156:159], v[80:83]
    ds_read_b64_tr_b16 v[154:155], v204 offset:1984
    v_mfma_f32_16x16x32_bf16 v[84:87], v[192:195], v[160:163], v[84:87]
    v_mfma_f32_16x16x32_bf16 v[88:91], v[192:195], v[164:167], v[88:91]
    s_add_u32 s36, s29, 128
    s_cmp_lt_u32 s36, 2048
    s_cselect_b32 s37, s28, s34
    s_add_u32 s36, s36, s37
    s_add_u32 s37, s24, s31
    s_add_u32 m0, s37, 0
    s_nop 0
    buffer_load_dwordx4 v236, s[4:7], s36 offen lds
    v_mfma_f32_16x16x32_bf16 v[92:95], v[192:195], v[168:171], v[92:95]
    v_mfma_f32_16x16x32_bf16 v[96:99], v[196:199], v[156:159], v[96:99]
    buffer_load_dwordx4 v237, s[4:7], s36 offen offset:1024 lds
    v_mfma_f32_16x16x32_bf16 v[100:103], v[196:199], v[160:163], v[100:103]
    v_mfma_f32_16x16x32_bf16 v[104:107], v[196:199], v[164:167], v[104:107]
    s_add_u32 s37, s32, s27
    s_add_u32 m0, s37, 14464
    s_mov_b64 exec, s[40:41]
    buffer_load_dwordx4 v238, s[8:11], s30 offen lds
    buffer_load_dwordx4 v239, s[8:11], s30 offen offset:896 lds
    buffer_load_dword v255, v253, s[64:67], s72 offen
    s_add_u32 s72, s72, s73
    s_mov_b64 exec, -1
    s_add_u32 s30, s30, 229376
    v_mfma_f32_16x16x32_bf16 v[108:111], v[196:199], v[168:171], v[108:111]
    s_cmp_lg_u32 s33, 11
    s_cbranch_scc1 .Lk2_mlp_nosw
    s_mov_b32 s64, s68
    s_mov_b32 s65, s69
    s_mov_b32 s66, s70
    s_mov_b32 s72, 0
    s_mov_b32 s73, s74
    v_mov_b32 v253, v254
.Lk2_mlp_nosw:
    s_cmp_lg_u32 s33, 3
    s_cbranch_scc1 .Lk2_mlp_nocp
    s_getpc_b64 s[88:89]
.Lpc_mlp:
    s_add_u32 s88, s88, .Lmid0-.Lpc_mlp
    s_addc_u32 s89, s89, -1
    v_lshlrev_b32 v242, 6, v240
    v_lshl_add_u32 v242, s3, 12, v242
    v_min_u32 v242, .Lk4_end-.Lmid0, v242
    v_mov_b32 v243, s89
    v_add_co_u32 v242, vcc, s88, v242
    s_nop 1
    v_addc_co_u32 v243, vcc, 0, v243, vcc
    global_load_dword v255, v[242:243], off
.Lk2_mlp_nocp:
    s_xor_b32 s27, s27, 28928
    s_mov_b32 s36, s24
    s_mov_b32 s24, s25
    s_mov_b32 s25, s26
    s_mov_b32 s26, s36
    s_add_u32 s29, s29, 128
    s_sub_u32 s33, s33, 1
    s_cmp_lg_u32 s33, 0
    s_cbranch_scc1 .Lk2_mlp_loop
    s_mov_b32 s48, 0xc0135761
    s_mov_b32 s49, 0xbdd2d3e8
    v_mov_b32 v245, s48
    s_lshl_b32 s36, s20, 1
    s_lshr_b32 s37, s22, 1
    s_add_u32 s36, s36, s37
    s_mul_i32 s36, s36, 144
    s_mul_i32 s37, s21, 7
    s_add_u32 s36, s36, s37
    s_add_u32 s37, s36, 6
    s_mul_i32 s38, s23, 3
    s_add_u32 s36, s36, s38
    s_lshl_b32 s36, s36, 13
    s_lshl_b32 s37, s37, 13
    s_add_u32 s36, s36, 0x00800000
    s_add_u32 s37, s37, 0x00800000
    s_lshl_b32 s38, s23, 3
    s_add_u32 s37, s37, s38
    v_lshrrev_b32 v241, 4, v240
    v_lshlrev_b32 v241, 11, v241
    v_and_b32 v242, 15, v240
    v_lshl_add_u32 v241, v242, 4, v241
    s_and_b32 s38, s22, 1
    s_lshl_b32 s38, s38, 10
    v_add_u32 v241, s38, v241
    s_waitcnt lgkmcnt(0)
    s_nop 7
    v_mul_f32 v112, v0, v0
    v_mul_f32 v113, v1, v1
    v_mul_f32 v114, v2, v2
    v_mul_f32 v115, v3, v3
    v_mul_f32 v116, v16, v16
    v_mul_f32 v117, v17, v17
    v_mul_f32 v118, v18, v18
    v_mul_f32 v119, v19, v19
    v_fma_f32 v112, v112, s49, v245
    v_fma_f32 v113, v113, s49, v245
    v_fma_f32 v114, v114, s49, v245
    v_fma_f32 v115, v115, s49, v245
    v_fma_f32 v116, v116, s49, v245
    v_fma_f32 v117, v117, s49, v245
    v_fma_f32 v118, v118, s49, v245
    v_fma_f32 v119, v119, s49, v245
    v_mul_f32 v112, v112, v0
    v_mul_f32 v113, v113, v1
    v_mul_f32 v114, v114, v2
    v_mul_f32 v115, v115, v3
    v_mul_f32 v116, v116, v16
    v_mul_f32 v117, v117, v17
    v_mul_f32 v118, v118, v18
    v_mul_f32 v119, v119, v19
    v_exp_f32 v112, v112
    v_exp_f32 v113, v113
    v_exp_f32 v114, v114
    v_exp_f32 v115, v115
    v_exp_f32 v116, v116
    v_exp_f32 v117, v117
    v_exp_f32 v118, v118
    v_exp_f32 v119, v119
    v_add_f32 v112, 1.0, v112
    v_add_f32 v113, 1.0, v113
    v_add_f32 v114, 1.0, v114
    v_add_f32 v115, 1.0, v115
    v_add_f32 v116, 1.0, v116
    v_add_f32 v117, 1.0, v117
    v_add_f32 v118, 1.0, v118
    v_add_f32 v119, 1.0, v119
    v_rcp_f32 v112, v112
    v_rcp_f32 v113, v113
    v_rcp_f32 v114, v114
    v_rcp_f32 v115, v115
    v_rcp_f32 v116, v116
    v_rcp_f32 v117, v117
    v_rcp_f32 v118, v118
    v_rcp_f32 v119, v119
    v_mul_f32 v112, v112, v0
    v_mul_f32 v113, v113, v1
    v_mul_f32 v114, v114, v2
    v_mul_f32 v115, v115, v3
    v_mul_f32 v116, v116, v16
    v_mul_f32 v117, v117, v17
    v_mul_f32 v118, v118, v18
    v_mul_f32 v119, v119, v19
    v_cvt_pk_bf16_f32 v128, v112, v113
    v_cvt_pk_bf16_f32 v129, v114, v115
    v_cvt_pk_bf16_f32 v130, v116, v117
    v_cvt_pk_bf16_f32 v131, v118, v119
    buffer_store_dwordx4 v[128:131], v241, s[12:15], s36 offen offset:0 sc1
    v_mul_f32 v120, v4, v4
    v_mul_f32 v121, v5, v5
    v_mul_f32 v122, v6, v6
    v_mul_f32 v123, v7, v7
    v_mul_f32 v124, v20, v20
    v_mul_f32 v125, v21, v21
    v_mul_f32 v126, v22, v22
    v_mul_f32 v127, v23, v23
    v_fma_f32 v120, v120, s49, v245
    v_fma_f32 v121, v121, s49, v245
    v_fma_f32 v122, v122, s49, v245
    v_fma_f32 v123, v123, s49, v245
    v_fma_f32 v124, v124, s49, v245
    v_fma_f32 v125, v125, s49, v245
    v_fma_f32 v126, v126, s49, v245
    v_fma_f32 v127, v127, s49, v245
    v_mul_f32 v120, v120, v4
    v_mul_f32 v121, v121, v5
    v_mul_f32 v122, v122, v6
    v_mul_f32 v123, v123, v7
    v_mul_f32 v124, v124, v20
    v_mul_f32 v125, v125, v21
    v_mul_f32 v126, v126, v22
    v_mul_f32 v127, v127, v23
    v_exp_f32 v120, v120
    v_exp_f32 v121, v121
    v_exp_f32 v122, v122
    v_exp_f32 v123, v123
    v_exp_f32 v124, v124
    v_exp_f32 v125, v125
    v_exp_f32 v126, v126
    v_exp_f32 v127, v127
    v_add_f32 v120, 1.0, v120
    v_add_f32 v121, 1.0, v121
    v_add_f32 v122, 1.0, v122
    v_add_f32 v123, 1.0, v123
    v_add_f32 v124, 1.0, v124
    v_add_f32 v125, 1.0, v125
    v_add_f32 v126, 1.0, v126
    v_add_f32 v127, 1.0, v127
    v_rcp_f32 v120, v120
    v_rcp_f32 v121, v121
    v_rcp_f32 v122, v122
    v_rcp_f32 v123, v123
    v_rcp_f32 v124, v124
    v_rcp_f32 v125, v125
    v_rcp_f32 v126, v126
    v_rcp_f32 v127, v127
    v_mul_f32 v120, v120, v4
    v_mul_f32 v121, v121, v5
    v_mul_f32 v122, v122, v6
    v_mul_f32 v123, v123, v7
    v_mul_f32 v124, v124, v20
    v_mul_f32 v125, v125, v21
    v_mul_f32 v126, v126, v22
    v_mul_f32 v127, v127, v23
    v_cvt_pk_bf16_f32 v132, v120, v121
    v_cvt_pk_bf16_f32 v133, v122, v123
    v_cvt_pk_bf16_f32 v134, v124, v125
    v_cvt_pk_bf16_f32 v135, v126, v127
    buffer_store_dwordx4 v[132:135], v241, s[12:15], s36 offen offset:256 sc1
    v_mul_f32 v112, v8, v8
    v_mul_f32 v113, v9, v9
    v_mul_f32 v114, v10, v10
    v_mul_f32 v115, v11, v11
    v_mul_f32 v116, v24, v24
    v_mul_f32 v117, v25, v25
    v_mul_f32 v118, v26, v26
    v_mul_f32 v119, v27, v27
    v_fma_f32 v112, v112, s49, v245
    v_fma_f32 v113, v113, s49, v245
    v_fma_f32 v114, v114, s49, v245
    v_fma_f32 v115, v115, s49, v245
    v_fma_f32 v116, v116, s49, v245
    v_fma_f32 v117, v117, s49, v245
    v_fma_f32 v118, v118, s49, v245
    v_fma_f32 v119, v119, s49, v245
    v_mul_f32 v112, v112, v8
    v_mul_f32 v113, v113, v9
    v_mul_f32 v114, v114, v10
    v_mul_f32 v115, v115, v11
    v_mul_f32 v116, v116, v24
    v_mul_f32 v117, v117, v25
    v_mul_f32 v118, v118, v26
    v_mul_f32 v119, v119, v27
    v_exp_f32 v112, v112
    v_exp_f32 v113, v113
    v_exp_f32 v114, v114
    v_exp_f32 v115, v115
    v_exp_f32 v116, v116
    v_exp_f32 v117, v117
    v_exp_f32 v118, v118
    v_exp_f32 v119, v119
    v_add_f32 v112, 1.0, v112
    v_add_f32 v113, 1.0, v113
    v_add_f32 v114, 1.0, v114
    v_add_f32 v115, 1.0, v115
    v_add_f32 v116, 1.0, v116
    v_add_f32 v117, 1.0, v117
    v_add_f32 v118, 1.0, v118
    v_add_f32 v119, 1.0, v119
    v_rcp_f32 v112, v112
    v_rcp_f32 v113, v113
    v_rcp_f32 v114, v114
    v_rcp_f32 v115, v115
    v_rcp_f32 v116, v116
    v_rcp_f32 v117, v117
    v_rcp_f32 v118, v118
    v_rcp_f32 v119, v119
    v_mul_f32 v112, v112, v8
    v_mul_f32 v113, v113, v9
    v_mul_f32 v114, v114, v10
    v_mul_f32 v115, v115, v11
    v_mul_f32 v116, v116, v24
    v_mul_f32 v117, v117, v25
    v_mul_f32 v118, v118, v26
    v_mul_f32 v119, v119, v27
    v_cvt_pk_bf16_f32 v136, v112, v113
    v_cvt_pk_bf16_f32 v137, v114, v115
    v_cvt_pk_bf16_f32 v138, v116, v117
    v_cvt_pk_bf16_f32 v139, v118, v119
    buffer_store_dwordx4 v[136:139], v241, s[12:15], s36 offen offset:512 sc1
    v_mul_f32 v120, v12, v12
    v_mul_f32 v121, v13, v13
    v_mul_f32 v122, v14, v14
    v_mul_f32 v123, v15, v15
    v_mul_f32 v124, v28, v28
    v_mul_f32 v125, v29, v29
    v_mul_f32 v126, v30, v30
    v_mul_f32 v127, v31, v31
    v_fma_f32 v120, v120, s49, v245
    v_fma_f32 v121, v121, s49, v245
    v_fma_f32 v122, v122, s49, v245
    v_fma_f32 v123, v123, s49, v245
    v_fma_f32 v124, v124, s49, v245
    v_fma_f32 v125, v125, s49, v245
    v_fma_f32 v126, v126, s49, v245
    v_fma_f32 v127, v127, s49, v245
    v_mul_f32 v120, v120, v12
    v_mul_f32 v121, v121, v13
    v_mul_f32 v122, v122, v14
    v_mul_f32 v123, v123, v15
    v_mul_f32 v124, v124, v28
    v_mul_f32 v125, v125, v29
    v_mul_f32 v126, v126, v30
    v_mul_f32 v127, v127, v31
    v_exp_f32 v120, v120
    v_exp_f32 v121, v121
    v_exp_f32 v122, v122
    v_exp_f32 v123, v123
    v_exp_f32 v124, v124
    v_exp_f32 v125, v125
    v_exp_f32 v126, v126
    v_exp_f32 v127, v127
    v_add_f32 v120, 1.0, v120
    v_add_f32 v121, 1.0, v121
    v_add_f32 v122, 1.0, v122
    v_add_f32 v123, 1.0, v123
    v_add_f32 v124, 1.0, v124
    v_add_f32 v125, 1.0, v125
    v_add_f32 v126, 1.0, v126
    v_add_f32 v127, 1.0, v127
    v_rcp_f32 v120, v120
    v_rcp_f32 v121, v121
    v_rcp_f32 v122, v122
    v_rcp_f32 v123, v123
    v_rcp_f32 v124, v124
    v_rcp_f32 v125, v125
    v_rcp_f32 v126, v126
    v_rcp_f32 v127, v127
    v_mul_f32 v120, v120, v12
    v_mul_f32 v121, v121, v13
    v_mul_f32 v122, v122, v14
    v_mul_f32 v123, v123, v15
    v_mul_f32 v124, v124, v28
    v_mul_f32 v125, v125, v29
    v_mul_f32 v126, v126, v30
    v_mul_f32 v127, v127, v31
    v_cvt_pk_bf16_f32 v140, v120, v121
    v_cvt_pk_bf16_f32 v141, v122, v123
    v_cvt_pk_bf16_f32 v142, v124, v125
    v_cvt_pk_bf16_f32 v143, v126, v127
    buffer_store_dwordx4 v[140:143], v241, s[12:15], s36 offen offset:768 sc1
    s_lshl_b32 s84, s20, 7
    s_add_u32 s84, s84, 0x03008000
    s_waitcnt vmcnt(4)
    s_barrier
    s_cmp_lt_u32 s3, 4
    s_cbranch_scc1 .Lk4e_m
    s_load_dwordx2 s[76:77], s[0:1], 56
    s_mov_b32 s78, 0x00700000
    s_mov_b32 s79, 0x00020000
    s_and_b32 s80, s2, 4
    s_lshr_b32 s81, s2, 6
    s_add_u32 s80, s80, s81
    s_and_b32 s82, s2, 1
    s_mul_i32 s82, s82, 3407872
    s_and_b32 s81, s3, 3
    s_lshl_b32 s83, s81, 12
    s_add_u32 s83, s83, 16384
    v_lshrrev_b32 v180, 4, v240
    v_and_b32 v181, 15, v240
    v_lshlrev_b32 v182, 1, v180
    v_xor_b32 v181, v181, v182
    s_lshl_b32 s81, s81, 4
    v_add_u32 v180, s81, v180
    v_lshlrev_b32 v180, 11, v180
    v_lshl_add_u32 v180, v181, 4, v180
    s_lshl_b32 s80, s80, 8
    v_add_u32 v176, s80, v180
    v_xor_b32 v177, 128, v176
    v_add_u32 v178, 14336, v176
    v_add_u32 v179, 21504, v177
    v_add_u32 v177, 7168, v177
    s_waitcnt lgkmcnt(0)
    s_add_u32 m0, s83, 0
    s_nop 0
    buffer_load_dwordx4 v176, s[76:79], s82 offen offset:0 lds
    buffer_load_dwordx4 v177, s[76:79], s82 offen offset:1024 lds
    buffer_load_dwordx4 v178, s[76:79], s82 offen offset:2048 lds
    buffer_load_dwordx4 v179, s[76:79], s82 offen offset:3072 lds
    s_add_u32 s82, s82, 131072
    s_add_u32 m0, s83, 32768
    s_nop 0
    buffer_load_dwordx4 v176, s[76:79], s82 offen offset:0 lds
    buffer_load_dwordx4 v177, s[76:79], s82 offen offset:1024 lds
    buffer_load_dwordx4 v178, s[76:79], s82 offen offset:2048 lds
    buffer_load_dwordx4 v179, s[76:79], s82 offen offset:3072 lds
    s_add_u32 s82, s82, 131072
    s_add_u32 m0, s83, 65536
    s_nop 0
    buffer_load_dwordx4 v176, s[76:79], s82 offen offset:0 lds
    buffer_load_dwordx4 v177, s[76:79], s82 offen offset:1024 lds
    buffer_load_dwordx4 v178, s[76:79], s82 offen offset:2048 lds
    buffer_load_dwordx4 v179, s[76:79], s82 offen offset:3072 lds
    s_add_u32 s82, s82, 131072
    s_add_u32 m0, s83, 98304
    s_nop 0
    buffer_load_dwordx4 v176, s[76:79], s82 offen offset:0 lds
    buffer_load_dwordx4 v177, s[76:79], s82 offen offset:1024 lds
    buffer_load_dwordx4 v178, s[76:79], s82 offen offset:2048 lds
    buffer_load_dwordx4 v179, s[76:79], s82 offen offset:3072 lds
    s_add_u32 s82, s82, 131072
    s_add_u32 m0, s83, 131072
    s_nop 0
    buffer_load_dwordx4 v176, s[76:79], s82 offen offset:0 lds
    buffer_load_dwordx4 v177, s[76:79], s82 offen offset:1024 lds
    buffer_load_dwordx4 v178, s[76:79], s82 offen offset:2048 lds
    buffer_load_dwordx4 v179, s[76:79], s82 offen offset:3072 lds
    s_add_u32 s82, s82, 131072
.Lk4e_m:
    s_add_u32 s36, s36, 8192
    v_mul_f32 v112, v32, v32
    v_mul_f32 v113, v33, v33
    v_mul_f32 v114, v34, v34
    v_mul_f32 v115, v35, v35
    v_mul_f32 v116, v48, v48
    v_mul_f32 v117, v49, v49
    v_mul_f32 v118, v50, v50
    v_mul_f32 v119, v51, v51
    v_fma_f32 v112, v112, s49, v245
    v_fma_f32 v113, v113, s49, v245
    v_fma_f32 v114, v114, s49, v245
    v_fma_f32 v115, v115, s49, v245
    v_fma_f32 v116, v116, s49, v245
    v_fma_f32 v117, v117, s49, v245
    v_fma_f32 v118, v118, s49, v245
    v_fma_f32 v119, v119, s49, v245
    v_mul_f32 v112, v112, v32
    v_mul_f32 v113, v113, v33
    v_mul_f32 v114, v114, v34
    v_mul_f32 v115, v115, v35
    v_mul_f32 v116, v116, v48
    v_mul_f32 v117, v117, v49
    v_mul_f32 v118, v118, v50
    v_mul_f32 v119, v119, v51
    v_exp_f32 v112, v112
    v_exp_f32 v113, v113
    v_exp_f32 v114, v114
    v_exp_f32 v115, v115
    v_exp_f32 v116, v116
    v_exp_f32 v117, v117
    v_exp_f32 v118, v118
    v_exp_f32 v119, v119
    v_add_f32 v112, 1.0, v112
    v_add_f32 v113, 1.0, v113
    v_add_f32 v114, 1.0, v114
    v_add_f32 v115, 1.0, v115
    v_add_f32 v116, 1.0, v116
    v_add_f32 v117, 1.0, v117
    v_add_f32 v118, 1.0, v118
    v_add_f32 v119, 1.0, v119
    v_rcp_f32 v112, v112
    v_rcp_f32 v113, v113
    v_rcp_f32 v114, v114
    v_rcp_f32 v115, v115
    v_rcp_f32 v116, v116
    v_rcp_f32 v117, v117
    v_rcp_f32 v118, v118
    v_rcp_f32 v119, v119
    v_mul_f32 v112, v112, v32
    v_mul_f32 v113, v113, v33
    v_mul_f32 v114, v114, v34
    v_mul_f32 v115, v115, v35
    v_mul_f32 v116, v116, v48
    v_mul_f32 v117, v117, v49
    v_mul_f32 v118, v118, v50
    v_mul_f32 v119, v119, v51
    v_cvt_pk_bf16_f32 v128, v112, v113
    v_cvt_pk_bf16_f32 v129, v114, v115
    v_cvt_pk_bf16_f32 v130, v116, v117
    v_cvt_pk_bf16_f32 v131, v118, v119
    buffer_store_dwordx4 v[128:131], v241, s[12:15], s36 offen offset:0 sc1
    v_mul_f32 v120, v36, v36
    v_mul_f32 v121, v37, v37
    v_mul_f32 v122, v38, v38
    v_mul_f32 v123, v39, v39
    v_mul_f32 v124, v52, v52
    v_mul_f32 v125, v53, v53
    v_mul_f32 v126, v54, v54
    v_mul_f32 v127, v55, v55
    v_fma_f32 v120, v120, s49, v245
    v_fma_f32 v121, v121, s49, v245
    v_fma_f32 v122, v122, s49, v245
    v_fma_f32 v123, v123, s49, v245
    v_fma_f32 v124, v124, s49, v245
    v_fma_f32 v125, v125, s49, v245
    v_fma_f32 v126, v126, s49, v245
    v_fma_f32 v127, v127, s49, v245
    v_mul_f32 v120, v120, v36
    v_mul_f32 v121, v121, v37
    v_mul_f32 v122, v122, v38
    v_mul_f32 v123, v123, v39
    v_mul_f32 v124, v124, v52
    v_mul_f32 v125, v125, v53
    v_mul_f32 v126, v126, v54
    v_mul_f32 v127, v127, v55
    v_exp_f32 v120, v120
    v_exp_f32 v121, v121
    v_exp_f32 v122, v122
    v_exp_f32 v123, v123
    v_exp_f32 v124, v124
    v_exp_f32 v125, v125
    v_exp_f32 v126, v126
    v_exp_f32 v127, v127
    v_add_f32 v120, 1.0, v120
    v_add_f32 v121, 1.0, v121
    v_add_f32 v122, 1.0, v122
    v_add_f32 v123, 1.0, v123
    v_add_f32 v124, 1.0, v124
    v_add_f32 v125, 1.0, v125
    v_add_f32 v126, 1.0, v126
    v_add_f32 v127, 1.0, v127
    v_rcp_f32 v120, v120
    v_rcp_f32 v121, v121
    v_rcp_f32 v122, v122
    v_rcp_f32 v123, v123
    v_rcp_f32 v124, v124
    v_rcp_f32 v125, v125
    v_rcp_f32 v126, v126
    v_rcp_f32 v127, v127
    v_mul_f32 v120, v120, v36
    v_mul_f32 v121, v121, v37
    v_mul_f32 v122, v122, v38
    v_mul_f32 v123, v123, v39
    v_mul_f32 v124, v124, v52
    v_mul_f32 v125, v125, v53
    v_mul_f32 v126, v126, v54
    v_mul_f32 v127, v127, v55
    v_cvt_pk_bf16_f32 v132, v120, v121
    v_cvt_pk_bf16_f32 v133, v122, v123
    v_cvt_pk_bf16_f32 v134, v124, v125
    v_cvt_pk_bf16_f32 v135, v126, v127
    buffer_store_dwordx4 v[132:135], v241, s[12:15], s36 offen offset:256 sc1
    v_mul_f32 v112, v40, v40
    v_mul_f32 v113, v41, v41
    v_mul_f32 v114, v42, v42
    v_mul_f32 v115, v43, v43
    v_mul_f32 v116, v56, v56
    v_mul_f32 v117, v57, v57
    v_mul_f32 v118, v58, v58
    v_mul_f32 v119, v59, v59
    v_fma_f32 v112, v112, s49, v245
    v_fma_f32 v113, v113, s49, v245
    v_fma_f32 v114, v114, s49, v245
    v_fma_f32 v115, v115, s49, v245
    v_fma_f32 v116, v116, s49, v245
    v_fma_f32 v117, v117, s49, v245
    v_fma_f32 v118, v118, s49, v245
    v_fma_f32 v119, v119, s49, v245
    v_mul_f32 v112, v112, v40
    v_mul_f32 v113, v113, v41
    v_mul_f32 v114, v114, v42
    v_mul_f32 v115, v115, v43
    v_mul_f32 v116, v116, v56
    v_mul_f32 v117, v117, v57
    v_mul_f32 v118, v118, v58
    v_mul_f32 v119, v119, v59
    v_exp_f32 v112, v112
    v_exp_f32 v113, v113
    v_exp_f32 v114, v114
    v_exp_f32 v115, v115
    v_exp_f32 v116, v116
    v_exp_f32 v117, v117
    v_exp_f32 v118, v118
    v_exp_f32 v119, v119
    v_add_f32 v112, 1.0, v112
    v_add_f32 v113, 1.0, v113
    v_add_f32 v114, 1.0, v114
    v_add_f32 v115, 1.0, v115
    v_add_f32 v116, 1.0, v116
    v_add_f32 v117, 1.0, v117
    v_add_f32 v118, 1.0, v118
    v_add_f32 v119, 1.0, v119
    v_rcp_f32 v112, v112
    v_rcp_f32 v113, v113
    v_rcp_f32 v114, v114
    v_rcp_f32 v115, v115
    v_rcp_f32 v116, v116
    v_rcp_f32 v117, v117
    v_rcp_f32 v118, v118
    v_rcp_f32 v119, v119
    v_mul_f32 v112, v112, v40
    v_mul_f32 v113, v113, v41
    v_mul_f32 v114, v114, v42
    v_mul_f32 v115, v115, v43
    v_mul_f32 v116, v116, v56
    v_mul_f32 v117, v117, v57
    v_mul_f32 v118, v118, v58
    v_mul_f32 v119, v119, v59
    v_cvt_pk_bf16_f32 v136, v112, v113
    v_cvt_pk_bf16_f32 v137, v114, v115
    v_cvt_pk_bf16_f32 v138, v116, v117
    v_cvt_pk_bf16_f32 v139, v118, v119
    buffer_store_dwordx4 v[136:139], v241, s[12:15], s36 offen offset:512 sc1
    v_mul_f32 v120, v44, v44
    v_mul_f32 v121, v45, v45
    v_mul_f32 v122, v46, v46
    v_mul_f32 v123, v47, v47
    v_mul_f32 v124, v60, v60
    v_mul_f32 v125, v61, v61
    v_mul_f32 v126, v62, v62
    v_mul_f32 v127, v63, v63
    v_fma_f32 v120, v120, s49, v245
    v_fma_f32 v121, v121, s49, v245
    v_fma_f32 v122, v122, s49, v245
    v_fma_f32 v123, v123, s49, v245
    v_fma_f32 v124, v124, s49, v245
    v_fma_f32 v125, v125, s49, v245
    v_fma_f32 v126, v126, s49, v245
    v_fma_f32 v127, v127, s49, v245
    v_mul_f32 v120, v120, v44
    v_mul_f32 v121, v121, v45
    v_mul_f32 v122, v122, v46
    v_mul_f32 v123, v123, v47
    v_mul_f32 v124, v124, v60
    v_mul_f32 v125, v125, v61
    v_mul_f32 v126, v126, v62
    v_mul_f32 v127, v127, v63
    v_exp_f32 v120, v120
    v_exp_f32 v121, v121
    v_exp_f32 v122, v122
    v_exp_f32 v123, v123
    v_exp_f32 v124, v124
    v_exp_f32 v125, v125
    v_exp_f32 v126, v126
    v_exp_f32 v127, v127
    v_add_f32 v120, 1.0, v120
    v_add_f32 v121, 1.0, v121
    v_add_f32 v122, 1.0, v122
    v_add_f32 v123, 1.0, v123
    v_add_f32 v124, 1.0, v124
    v_add_f32 v125, 1.0, v125
    v_add_f32 v126, 1.0, v126
    v_add_f32 v127, 1.0, v127
    v_rcp_f32 v120, v120
    v_rcp_f32 v121, v121
    v_rcp_f32 v122, v122
    v_rcp_f32 v123, v123
    v_rcp_f32 v124, v124
    v_rcp_f32 v125, v125
    v_rcp_f32 v126, v126
    v_rcp_f32 v127, v127
    v_mul_f32 v120, v120, v44
    v_mul_f32 v121, v121, v45
    v_mul_f32 v122, v122, v46
    v_mul_f32 v123, v123, v47
    v_mul_f32 v124, v124, v60
    v_mul_f32 v125, v125, v61
    v_mul_f32 v126, v126, v62
    v_mul_f32 v127, v127, v63
    v_cvt_pk_bf16_f32 v140, v120, v121
    v_cvt_pk_bf16_f32 v141, v122, v123
    v_cvt_pk_bf16_f32 v142, v124, v125
    v_cvt_pk_bf16_f32 v143, v126, v127
    buffer_store_dwordx4 v[140:143], v241, s[12:15], s36 offen offset:768 sc1
    s_add_u32 s36, s36, 8192
    v_mul_f32 v112, v64, v64
    v_mul_f32 v113, v65, v65
    v_mul_f32 v114, v66, v66
    v_mul_f32 v115, v67, v67
    v_mul_f32 v116, v80, v80
    v_mul_f32 v117, v81, v81
    v_mul_f32 v118, v82, v82
    v_mul_f32 v119, v83, v83
    v_fma_f32 v112, v112, s49, v245
    v_fma_f32 v113, v113, s49, v245
    v_fma_f32 v114, v114, s49, v245
    v_fma_f32 v115, v115, s49, v245
    v_fma_f32 v116, v116, s49, v245
    v_fma_f32 v117, v117, s49, v245
    v_fma_f32 v118, v118, s49, v245
    v_fma_f32 v119, v119, s49, v245
    v_mul_f32 v112, v112, v64
    v_mul_f32 v113, v113, v65
    v_mul_f32 v114, v114, v66
    v_mul_f32 v115, v115, v67
    v_mul_f32 v116, v116, v80
    v_mul_f32 v117, v117, v81
    v_mul_f32 v118, v118, v82
    v_mul_f32 v119, v119, v83
    v_exp_f32 v112, v112
    v_exp_f32 v113, v113
    v_exp_f32 v114, v114
    v_exp_f32 v115, v115
    v_exp_f32 v116, v116
    v_exp_f32 v117, v117
    v_exp_f32 v118, v118
    v_exp_f32 v119, v119
    v_add_f32 v112, 1.0, v112
    v_add_f32 v113, 1.0, v113
    v_add_f32 v114, 1.0, v114
    v_add_f32 v115, 1.0, v115
    v_add_f32 v116, 1.0, v116
    v_add_f32 v117, 1.0, v117
    v_add_f32 v118, 1.0, v118
    v_add_f32 v119, 1.0, v119
    v_rcp_f32 v112, v112
    v_rcp_f32 v113, v113
    v_rcp_f32 v114, v114
    v_rcp_f32 v115, v115
    v_rcp_f32 v116, v116
    v_rcp_f32 v117, v117
    v_rcp_f32 v118, v118
    v_rcp_f32 v119, v119
    v_mul_f32 v112, v112, v64
    v_mul_f32 v113, v113, v65
    v_mul_f32 v114, v114, v66
    v_mul_f32 v115, v115, v67
    v_mul_f32 v116, v116, v80
    v_mul_f32 v117, v117, v81
    v_mul_f32 v118, v118, v82
    v_mul_f32 v119, v119, v83
    v_cvt_pk_bf16_f32 v128, v112, v113
    v_cvt_pk_bf16_f32 v129, v114, v115
    v_cvt_pk_bf16_f32 v130, v116, v117
    v_cvt_pk_bf16_f32 v131, v118, v119
    buffer_store_dwordx4 v[128:131], v241, s[12:15], s36 offen offset:0 sc1
    v_mul_f32 v120, v68, v68
    v_mul_f32 v121, v69, v69
    v_mul_f32 v122, v70, v70
    v_mul_f32 v123, v71, v71
    v_mul_f32 v124, v84, v84
    v_mul_f32 v125, v85, v85
    v_mul_f32 v126, v86, v86
    v_mul_f32 v127, v87, v87
    v_fma_f32 v120, v120, s49, v245
    v_fma_f32 v121, v121, s49, v245
    v_fma_f32 v122, v122, s49, v245
    v_fma_f32 v123, v123, s49, v245
    v_fma_f32 v124, v124, s49, v245
    v_fma_f32 v125, v125, s49, v245
    v_fma_f32 v126, v126, s49, v245
    v_fma_f32 v127, v127, s49, v245
    v_mul_f32 v120, v120, v68
    v_mul_f32 v121, v121, v69
    v_mul_f32 v122, v122, v70
    v_mul_f32 v123, v123, v71
    v_mul_f32 v124, v124, v84
    v_mul_f32 v125, v125, v85
    v_mul_f32 v126, v126, v86
    v_mul_f32 v127, v127, v87
    v_exp_f32 v120, v120
    v_exp_f32 v121, v121
    v_exp_f32 v122, v122
    v_exp_f32 v123, v123
    v_exp_f32 v124, v124
    v_exp_f32 v125, v125
    v_exp_f32 v126, v126
    v_exp_f32 v127, v127
    v_add_f32 v120, 1.0, v120
    v_add_f32 v121, 1.0, v121
    v_add_f32 v122, 1.0, v122
    v_add_f32 v123, 1.0, v123
    v_add_f32 v124, 1.0, v124
    v_add_f32 v125, 1.0, v125
    v_add_f32 v126, 1.0, v126
    v_add_f32 v127, 1.0, v127
    v_rcp_f32 v120, v120
    v_rcp_f32 v121, v121
    v_rcp_f32 v122, v122
    v_rcp_f32 v123, v123
    v_rcp_f32 v124, v124
    v_rcp_f32 v125, v125
    v_rcp_f32 v126, v126
    v_rcp_f32 v127, v127
    v_mul_f32 v120, v120, v68
    v_mul_f32 v121, v121, v69
    v_mul_f32 v122, v122, v70
    v_mul_f32 v123, v123, v71
    v_mul_f32 v124, v124, v84
    v_mul_f32 v125, v125, v85
    v_mul_f32 v126, v126, v86
    v_mul_f32 v127, v127, v87
    v_cvt_pk_bf16_f32 v132, v120, v121
    v_cvt_pk_bf16_f32 v133, v122, v123
    v_cvt_pk_bf16_f32 v134, v124, v125
    v_cvt_pk_bf16_f32 v135, v126, v127
    buffer_store_dwordx4 v[132:135], v241, s[12:15], s36 offen offset:256 sc1
    v_mul_f32 v112, v72, v72
    v_mul_f32 v113, v73, v73
    v_mul_f32 v114, v74, v74
    v_mul_f32 v115, v75, v75
    v_mul_f32 v116, v88, v88
    v_mul_f32 v117, v89, v89
    v_mul_f32 v118, v90, v90
    v_mul_f32 v119, v91, v91
    v_fma_f32 v112, v112, s49, v245
    v_fma_f32 v113, v113, s49, v245
    v_fma_f32 v114, v114, s49, v245
    v_fma_f32 v115, v115, s49, v245
    v_fma_f32 v116, v116, s49, v245
    v_fma_f32 v117, v117, s49, v245
    v_fma_f32 v118, v118, s49, v245
    v_fma_f32 v119, v119, s49, v245
    v_mul_f32 v112, v112, v72
    v_mul_f32 v113, v113, v73
    v_mul_f32 v114, v114, v74
    v_mul_f32 v115, v115, v75
    v_mul_f32 v116, v116, v88
    v_mul_f32 v117, v117, v89
    v_mul_f32 v118, v118, v90
    v_mul_f32 v119, v119, v91
    v_exp_f32 v112, v112
    v_exp_f32 v113, v113
    v_exp_f32 v114, v114
    v_exp_f32 v115, v115
    v_exp_f32 v116, v116
    v_exp_f32 v117, v117
    v_exp_f32 v118, v118
    v_exp_f32 v119, v119
    v_add_f32 v112, 1.0, v112
    v_add_f32 v113, 1.0, v113
    v_add_f32 v114, 1.0, v114
    v_add_f32 v115, 1.0, v115
    v_add_f32 v116, 1.0, v116
    v_add_f32 v117, 1.0, v117
    v_add_f32 v118, 1.0, v118
    v_add_f32 v119, 1.0, v119
    v_rcp_f32 v112, v112
    v_rcp_f32 v113, v113
    v_rcp_f32 v114, v114
    v_rcp_f32 v115, v115
    v_rcp_f32 v116, v116
    v_rcp_f32 v117, v117
    v_rcp_f32 v118, v118
    v_rcp_f32 v119, v119
    v_mul_f32 v112, v112, v72
    v_mul_f32 v113, v113, v73
    v_mul_f32 v114, v114, v74
    v_mul_f32 v115, v115, v75
    v_mul_f32 v116, v116, v88
    v_mul_f32 v117, v117, v89
    v_mul_f32 v118, v118, v90
    v_mul_f32 v119, v119, v91
    v_cvt_pk_bf16_f32 v136, v112, v113
    v_cvt_pk_bf16_f32 v137, v114, v115
    v_cvt_pk_bf16_f32 v138, v116, v117
    v_cvt_pk_bf16_f32 v139, v118, v119
    buffer_store_dwordx4 v[136:139], v241, s[12:15], s36 offen offset:512 sc1
    v_mul_f32 v120, v76, v76
    v_mul_f32 v121, v77, v77
    v_mul_f32 v122, v78, v78
    v_mul_f32 v123, v79, v79
    v_mul_f32 v124, v92, v92
    v_mul_f32 v125, v93, v93
    v_mul_f32 v126, v94, v94
    v_mul_f32 v127, v95, v95
    v_fma_f32 v120, v120, s49, v245
    v_fma_f32 v121, v121, s49, v245
    v_fma_f32 v122, v122, s49, v245
    v_fma_f32 v123, v123, s49, v245
    v_fma_f32 v124, v124, s49, v245
    v_fma_f32 v125, v125, s49, v245
    v_fma_f32 v126, v126, s49, v245
    v_fma_f32 v127, v127, s49, v245
    v_mul_f32 v120, v120, v76
    v_mul_f32 v121, v121, v77
    v_mul_f32 v122, v122, v78
    v_mul_f32 v123, v123, v79
    v_mul_f32 v124, v124, v92
    v_mul_f32 v125, v125, v93
    v_mul_f32 v126, v126, v94
    v_mul_f32 v127, v127, v95
    v_exp_f32 v120, v120
    v_exp_f32 v121, v121
    v_exp_f32 v122, v122
    v_exp_f32 v123, v123
    v_exp_f32 v124, v124
    v_exp_f32 v125, v125
    v_exp_f32 v126, v126
    v_exp_f32 v127, v127
    v_add_f32 v120, 1.0, v120
    v_add_f32 v121, 1.0, v121
    v_add_f32 v122, 1.0, v122
    v_add_f32 v123, 1.0, v123
    v_add_f32 v124, 1.0, v124
    v_add_f32 v125, 1.0, v125
    v_add_f32 v126, 1.0, v126
    v_add_f32 v127, 1.0, v127
    v_rcp_f32 v120, v120
    v_rcp_f32 v121, v121
    v_rcp_f32 v122, v122
    v_rcp_f32 v123, v123
    v_rcp_f32 v124, v124
    v_rcp_f32 v125, v125
    v_rcp_f32 v126, v126
    v_rcp_f32 v127, v127
    v_mul_f32 v120, v120, v76
    v_mul_f32 v121, v121, v77
    v_mul_f32 v122, v122, v78
    v_mul_f32 v123, v123, v79
    v_mul_f32 v124, v124, v92
    v_mul_f32 v125, v125, v93
    v_mul_f32 v126, v126, v94
    v_mul_f32 v127, v127, v95
    v_cvt_pk_bf16_f32 v140, v120, v121
    v_cvt_pk_bf16_f32 v141, v122, v123
    v_cvt_pk_bf16_f32 v142, v124, v125
    v_cvt_pk_bf16_f32 v143, v126, v127
    buffer_store_dwordx4 v[140:143], v241, s[12:15], s36 offen offset:768 sc1
    v_mul_f32 v112, v96, v96
    v_mul_f32 v113, v97, v97
    v_mul_f32 v114, v98, v98
    v_mul_f32 v115, v99, v99
    v_mul_f32 v116, v100, v100
    v_mul_f32 v117, v101, v101
    v_mul_f32 v118, v102, v102
    v_mul_f32 v119, v103, v103
    v_fma_f32 v112, v112, s49, v245
    v_fma_f32 v113, v113, s49, v245
    v_fma_f32 v114, v114, s49, v245
    v_fma_f32 v115, v115, s49, v245
    v_fma_f32 v116, v116, s49, v245
    v_fma_f32 v117, v117, s49, v245
    v_fma_f32 v118, v118, s49, v245
    v_fma_f32 v119, v119, s49, v245
    v_mul_f32 v112, v112, v96
    v_mul_f32 v113, v113, v97
    v_mul_f32 v114, v114, v98
    v_mul_f32 v115, v115, v99
    v_mul_f32 v116, v116, v100
    v_mul_f32 v117, v117, v101
    v_mul_f32 v118, v118, v102
    v_mul_f32 v119, v119, v103
    v_exp_f32 v112, v112
    v_exp_f32 v113, v113
    v_exp_f32 v114, v114
    v_exp_f32 v115, v115
    v_exp_f32 v116, v116
    v_exp_f32 v117, v117
    v_exp_f32 v118, v118
    v_exp_f32 v119, v119
    v_add_f32 v112, 1.0, v112
    v_add_f32 v113, 1.0, v113
    v_add_f32 v114, 1.0, v114
    v_add_f32 v115, 1.0, v115
    v_add_f32 v116, 1.0, v116
    v_add_f32 v117, 1.0, v117
    v_add_f32 v118, 1.0, v118
    v_add_f32 v119, 1.0, v119
    v_rcp_f32 v112, v112
    v_rcp_f32 v113, v113
    v_rcp_f32 v114, v114
    v_rcp_f32 v115, v115
    v_rcp_f32 v116, v116
    v_rcp_f32 v117, v117
    v_rcp_f32 v118, v118
    v_rcp_f32 v119, v119
    v_mul_f32 v112, v112, v96
    v_mul_f32 v113, v113, v97
    v_mul_f32 v114, v114, v98
    v_mul_f32 v115, v115, v99
    v_mul_f32 v116, v116, v100
    v_mul_f32 v117, v117, v101
    v_mul_f32 v118, v118, v102
    v_mul_f32 v119, v119, v103
    v_cvt_pk_bf16_f32 v128, v112, v113
    v_cvt_pk_bf16_f32 v129, v114, v115
    v_cvt_pk_bf16_f32 v130, v116, v117
    v_cvt_pk_bf16_f32 v131, v118, v119
    buffer_store_dwordx2 v[128:129], v241, s[12:15], s37 offen offset:0 sc1
    buffer_store_dwordx2 v[130:131], v241, s[12:15], s37 offen offset:256 sc1
    v_mul_f32 v120, v104, v104
    v_mul_f32 v121, v105, v105
    v_mul_f32 v122, v106, v106
    v_mul_f32 v123, v107, v107
    v_mul_f32 v124, v108, v108
    v_mul_f32 v125, v109, v109
    v_mul_f32 v126, v110, v110
    v_mul_f32 v127, v111, v111
    v_fma_f32 v120, v120, s49, v245
    v_fma_f32 v121, v121, s49, v245
    v_fma_f32 v122, v122, s49, v245
    v_fma_f32 v123, v123, s49, v245
    v_fma_f32 v124, v124, s49, v245
    v_fma_f32 v125, v125, s49, v245
    v_fma_f32 v126, v126, s49, v245
    v_fma_f32 v127, v127, s49, v245
    v_mul_f32 v120, v120, v104
    v_mul_f32 v121, v121, v105
    v_mul_f32 v122, v122, v106
    v_mul_f32 v123, v123, v107
    v_mul_f32 v124, v124, v108
    v_mul_f32 v125, v125, v109
    v_mul_f32 v126, v126, v110
    v_mul_f32 v127, v127, v111
    v_exp_f32 v120, v120
    v_exp_f32 v121, v121
    v_exp_f32 v122, v122
    v_exp_f32 v123, v123
    v_exp_f32 v124, v124
    v_exp_f32 v125, v125
    v_exp_f32 v126, v126
    v_exp_f32 v127, v127
    v_add_f32 v120, 1.0, v120
    v_add_f32 v121, 1.0, v121
    v_add_f32 v122, 1.0, v122
    v_add_f32 v123, 1.0, v123
    v_add_f32 v124, 1.0, v124
    v_add_f32 v125, 1.0, v125
    v_add_f32 v126, 1.0, v126
    v_add_f32 v127, 1.0, v127
    v_rcp_f32 v120, v120
    v_rcp_f32 v121, v121
    v_rcp_f32 v122, v122
    v_rcp_f32 v123, v123
    v_rcp_f32 v124, v124
    v_rcp_f32 v125, v125
    v_rcp_f32 v126, v126
    v_rcp_f32 v127, v127
    v_mul_f32 v120, v120, v104
    v_mul_f32 v121, v121, v105
    v_mul_f32 v122, v122, v106
    v_mul_f32 v123, v123, v107
    v_mul_f32 v124, v124, v108
    v_mul_f32 v125, v125, v109
    v_mul_f32 v126, v126, v110
    v_mul_f32 v127, v127, v111
    v_cvt_pk_bf16_f32 v132, v120, v121
    v_cvt_pk_bf16_f32 v133, v122, v123
    v_cvt_pk_bf16_f32 v134, v124, v125
    v_cvt_pk_bf16_f32 v135, v126, v127
    buffer_store_dwordx2 v[132:133], v241, s[12:15], s37 offen offset:512 sc1
    buffer_store_dwordx2 v[134:135], v241, s[12:15], s37 offen offset:768 sc1
    s_branch .Lk2_end
.Lk2_att:
    s_load_dwordx2 s[8:9], s[0:1], 8
    s_load_dwordx2 s[16:17], s[0:1], 16
    s_mov_b32 s10, 0x00600000
    s_mov_b32 s11, 0x00020000
    s_mov_b32 s18, 65536
    s_mov_b32 s19, 0x00020000
    s_mov_b32 s40, -1
    s_mov_b32 s41, 0x0000ffff
    s_load_dwordx2 s[64:65], s[0:1], 8
    s_load_dwordx2 s[68:69], s[0:1], 24
    s_mov_b32 s66, 0x00600000
    s_mov_b32 s67, 0x00020000
    s_mov_b32 s70, 0x00200000
    s_mov_b32 s71, 0x00020000
    s_mov_b32 s72, 0x000c0000
    s_mov_b32 s73, 0x00060000
    s_mov_b32 s74, 0x00060000
    s_lshl_b32 s36, s20, 3
    s_add_u32 s36, s36, s3
    s_lshl_b32 s37, s21, 6
    s_add_u32 s37, s37, s36
    s_mul_i32 s37, s37, 384
    s_mul_i32 s36, s36, 6144
    s_mul_i32 s38, s21, 128
    s_add_u32 s36, s36, s38
    v_lshlrev_b32 v241, 6, v240
    v_add_u32 v254, s37, v241
    v_lshrrev_b32 v241, 1, v240
    v_lshlrev_b32 v241, 11, v241
    v_and_b32 v242, 1, v240
    v_lshl_add_u32 v241, v242, 6, v241
    v_add_u32 v253, s36, v241
    v_mov_b32 v241, s34
    v_cmp_gt_u32 vcc, 6, v240
    s_nop 1
    v_cndmask_b32 v253, v241, v253, vcc
    v_cndmask_b32 v254, v241, v254, vcc
    v_cmp_le_u32 vcc, 24, v240
    s_nop 1
    v_cndmask_b32 v241, 0, 1, vcc
    v_mul_u32_u24 v242, 24, v241
    v_sub_u32 v242, v240, v242
    v_lshrrev_b32 v243, 3, v242
    v_min_u32 v243, 2, v243
    v_and_b32 v242, 7, v242
    v_lshlrev_b32 v243, 11, v243
    v_lshl_add_u32 v243, v242, 4, v243
    s_lshl_b32 s36, s3, 2
    v_add_u32 v241, s36, v241
    v_mul_u32_u24 v241, 6144, v241
    s_lshl_b32 s36, s21, 7
    v_add_u32 v241, s36, v241
    v_add_u32 v238, v241, v243
    v_xor_b32 v243, 64, v243
    v_add_u32 v239, v241, v243
    v_add_u32 v239, 11520, v239
    s_mul_i32 s32, s3, 1536
    s_add_u32 s32, s32, 98304
    v_and_b32 v241, 31, v240
    v_bfe_u32 v242, v240, 1, 3
    v_lshrrev_b32 v243, 5, v240
    v_xor_b32 v242, v242, v243
    s_lshl_b32 s36, s22, 6
    v_add_u32 v241, s36, v241
    v_lshlrev_b32 v241, 7, v241
    v_lshl_add_u32 v180, v242, 4, v241
    v_xor_b32 v181, 32, v180
    v_xor_b32 v182, 64, v180
    v_xor_b32 v183, 0x60, v180
    v_mov_b32 v176, v180
    v_mov_b32 v177, v181
    v_mov_b32 v178, v182
    v_mov_b32 v179, v183
    v_bfe_u32 v241, v240, 2, 2
    v_lshl_add_u32 v241, v243, 3, v241
    v_mul_u32_u24 v241, 384, v241
    v_bfe_u32 v242, v240, 3, 1
    v_xor_b32 v242, s23, v242
    v_lshl_add_u32 v241, v242, 6, v241
    v_bfe_u32 v242, v240, 4, 1
    v_lshl_add_u32 v241, v242, 5, v241
    v_and_b32 v242, 3, v240
    v_lshl_add_u32 v241, v242, 3, v241
    v_add_u32 v185, 98304, v241
    v_mov_b32 v184, v185
    s_lshl_b32 s36, s21, 12
    s_lshl_b32 s37, s3, 9
    s_add_u32 s36, s36, s37
    s_add_u32 m0, s37, 147456
    v_lshlrev_b32 v241, 4, v240
    s_waitcnt lgkmcnt(0)
    s_mov_b32 exec_hi, 0
    buffer_load_dwordx4 v241, s[16:19], s36 offen lds
    s_mov_b64 exec, -1
    s_mov_b32 s29, 0
    s_mov_b32 s27, 0
    s_add_u32 s36, s29, 0
    s_cmp_lt_u32 s36, 2048
    s_cselect_b32 s37, s28, s34
    s_add_u32 s36, s36, s37
    s_add_u32 s37, s24, s31
    s_add_u32 m0, s37, 0
    s_nop 0
    buffer_load_dwordx4 v236, s[4:7], s36 offen lds
    buffer_load_dwordx4 v237, s[4:7], s36 offen offset:1024 lds
    s_add_u32 s36, s29, 0
    s_cmp_lt_u32 s36, 2048
    s_cselect_b32 s37, s28, s34
    s_add_u32 s36, s36, s37
    s_add_u32 s36, s36, 262144
    s_add_u32 s37, s24, s31
    s_add_u32 m0, s37, 16384
    s_nop 0
    buffer_load_dwordx4 v236, s[4:7], s36 offen lds
    buffer_load_dwordx4 v237, s[4:7], s36 offen offset:1024 lds
    s_add_u32 s37, s32, s27
    s_add_u32 m0, s37, 0
    s_mov_b64 exec, s[40:41]
    buffer_load_dwordx4 v238, s[8:11], s30 offen lds
    buffer_load_dwordx4 v239, s[8:11], s30 offen offset:768 lds
    buffer_load_dword v255, v253, s[64:67], s34 offen
    s_mov_b64 exec, -1
    s_add_u32 s30, s30, 196608
    s_add_u32 s36, s29, 128
    s_cmp_lt_u32 s36, 2048
    s_cselect_b32 s37, s28, s34
    s_add_u32 s36, s36, s37
    s_add_u32 s37, s25, s31
    s_add_u32 m0, s37, 0
    s_nop 0
    buffer_load_dwordx4 v236, s[4:7], s36 offen lds
    buffer_load_dwordx4 v237, s[4:7], s36 offen offset:1024 lds
    s_add_u32 s37, s32, s27
    s_add_u32 m0, s37, 12288
    s_mov_b64 exec, s[40:41]
    buffer_load_dwordx4 v238, s[8:11], s30 offen lds
    buffer_load_dwordx4 v239, s[8:11], s30 offen offset:768 lds
    buffer_load_dword v255, v253, s[64:67], s34 offen
    s_mov_b64 exec, -1
    s_add_u32 s30, s30, 196608
    s_add_u32 s36, s29, 128
    s_cmp_lt_u32 s36, 2048
    s_cselect_b32 s37, s28, s34
    s_add_u32 s36, s36, s37
    s_add_u32 s36, s36, 262144
    s_add_u32 s37, s25, s31
    s_add_u32 m0, s37, 16384
    s_nop 0
    buffer_load_dwordx4 v236, s[4:7], s36 offen lds
    buffer_load_dwordx4 v237, s[4:7], s36 offen offset:1024 lds
    s_add_u32 s37, s32, s27
    s_add_u32 m0, s37, 24576
    s_mov_b64 exec, s[40:41]
    buffer_load_dwordx4 v238, s[8:11], s30 offen lds
    buffer_load_dwordx4 v239, s[8:11], s30 offen offset:768 lds
    buffer_load_dword v255, v253, s[64:67], s72 offen
    s_add_u32 s72, s72, s73
    s_mov_b64 exec, -1
    s_add_u32 s30, s30, 196608
    s_add_u32 s36, s29, 256
    s_cmp_lt_u32 s36, 2048
    s_cselect_b32 s37, s28, s34
    s_add_u32 s36, s36, s37
    s_add_u32 s37, s26, s31
    s_add_u32 m0, s37, 0
    s_nop 0
    buffer_load_dwordx4 v236, s[4:7], s36 offen lds
    buffer_load_dwordx4 v237, s[4:7], s36 offen offset:1024 lds
    s_add_u32 s37, s32, s27
    s_add_u32 m0, s37, 36864
    s_mov_b64 exec, s[40:41]
    buffer_load_dwordx4 v238, s[8:11], s30 offen lds
    buffer_load_dwordx4 v239, s[8:11], s30 offen offset:768 lds
    buffer_load_dword v255, v253, s[64:67], s72 offen
    s_add_u32 s72, s72, s73
    s_mov_b64 exec, -1
    s_add_u32 s30, s30, 196608
    s_mov_b32 s29, 256
    v_mov_b32 v0, 0
    v_mov_b32 v1, 0
    v_mov_b32 v2, 0
    v_mov_b32 v3, 0
    v_mov_b32 v4, 0
    v_mov_b32 v5, 0
    v_mov_b32 v6, 0
    v_mov_b32 v7, 0
    v_mov_b32 v8, 0
    v_mov_b32 v9, 0
    v_mov_b32 v10, 0
    v_mov_b32 v11, 0
    v_mov_b32 v12, 0
    v_mov_b32 v13, 0
    v_mov_b32 v14, 0
    v_mov_b32 v15, 0
    v_mov_b32 v16, 0
    v_mov_b32 v17, 0
    v_mov_b32 v18, 0
    v_mov_b32 v19, 0
    v_mov_b32 v20, 0
    v_mov_b32 v21, 0
    v_mov_b32 v22, 0
    v_mov_b32 v23, 0
    v_mov_b32 v24, 0
    v_mov_b32 v25, 0
    v_mov_b32 v26, 0
    v_mov_b32 v27, 0
    v_mov_b32 v28, 0
    v_mov_b32 v29, 0
    v_mov_b32 v30, 0
    v_mov_b32 v31, 0
    v_mov_b32 v32, 0
    v_mov_b32 v33, 0
    v_mov_b32 v34, 0
    v_mov_b32 v35, 0
    v_mov_b32 v36, 0
    v_mov_b32 v37, 0
    v_mov_b32 v38, 0
    v_mov_b32 v39, 0
    v_mov_b32 v40, 0
    v_mov_b32 v41, 0
    v_mov_b32 v42, 0
    v_mov_b32 v43, 0
    v_mov_b32 v44, 0
    v_mov_b32 v45, 0
    v_mov_b32 v46, 0
    v_mov_b32 v47, 0
    v_mov_b32 v48, 0
    v_mov_b32 v49, 0
    v_mov_b32 v50, 0
    v_mov_b32 v51, 0
    v_mov_b32 v52, 0
    v_mov_b32 v53, 0
    v_mov_b32 v54, 0
    v_mov_b32 v55, 0
    v_mov_b32 v56, 0
    v_mov_b32 v57, 0
    v_mov_b32 v58, 0
    v_mov_b32 v59, 0
    v_mov_b32 v60, 0
    v_mov_b32 v61, 0
    v_mov_b32 v62, 0
    v_mov_b32 v63, 0
    v_mov_b32 v64, 0
    v_mov_b32 v65, 0
    v_mov_b32 v66, 0
    v_mov_b32 v67, 0
    v_mov_b32 v68, 0
    v_mov_b32 v69, 0
    v_mov_b32 v70, 0
    v_mov_b32 v71, 0
    v_mov_b32 v72, 0
    v_mov_b32 v73, 0
    v_mov_b32 v74, 0
    v_mov_b32 v75, 0
    v_mov_b32 v76, 0
    v_mov_b32 v77, 0
    v_mov_b32 v78, 0
    v_mov_b32 v79, 0
    v_mov_b32 v80, 0
    v_mov_b32 v81, 0
    v_mov_b32 v82, 0
    v_mov_b32 v83, 0
    v_mov_b32 v84, 0
    v_mov_b32 v85, 0
    v_mov_b32 v86, 0
    v_mov_b32 v87, 0
    v_mov_b32 v88, 0
    v_mov_b32 v89, 0
    v_mov_b32 v90, 0
    v_mov_b32 v91, 0
    v_mov_b32 v92, 0
    v_mov_b32 v93, 0
    v_mov_b32 v94, 0
    v_mov_b32 v95, 0
    s_waitcnt vmcnt(15)
    s_barrier
    ds_read_b64_tr_b16 v[112:113], v184 offset:0
    ds_read_b64_tr_b16 v[114:115], v184 offset:1536
    ds_read_b128 v[96:99], v176 offset:0
    ds_read_b128 v[100:103], v176 offset:4096
    ds_read_b64_tr_b16 v[116:117], v184 offset:128
    ds_read_b64_tr_b16 v[118:119], v184 offset:1664
    ds_read_b64_tr_b16 v[120:121], v184 offset:256
    ds_read_b64_tr_b16 v[122:123], v184 offset:1792
    ds_read_b64_tr_b16 v[124:125], v184 offset:6144
    ds_read_b64_tr_b16 v[126:127], v184 offset:7680
    ds_read_b128 v[104:107], v177 offset:0
    ds_read_b128 v[108:111], v177 offset:4096
    ds_read_b64_tr_b16 v[128:129], v184 offset:6272
    ds_read_b64_tr_b16 v[130:131], v184 offset:7808
    ds_read_b64_tr_b16 v[132:133], v184 offset:6400
    ds_read_b64_tr_b16 v[134:135], v184 offset:7936
    s_mov_b32 s33, 16
.Lk2_att_loop:
    s_waitcnt lgkmcnt(0)
    v_mfma_f32_32x32x16_bf16 v[0:15], v[112:115], v[96:99], v[0:15]
    v_mfma_f32_32x32x16_bf16 v[16:31], v[112:115], v[100:103], v[16:31]
    s_waitcnt vmcnt(10)
    s_barrier
    ds_read_b64_tr_b16 v[152:153], v184 offset:12288
    ds_read_b64_tr_b16 v[154:155], v184 offset:13824
    v_mfma_f32_32x32x16_bf16 v[32:47], v[116:119], v[96:99], v[32:47]
    ds_read_b128 v[136:139], v178 offset:0
    ds_read_b128 v[140:143], v178 offset:4096
    v_mfma_f32_32x32x16_bf16 v[48:63], v[116:119], v[100:103], v[48:63]
    ds_read_b64_tr_b16 v[156:157], v184 offset:12416
    ds_read_b64_tr_b16 v[158:159], v184 offset:13952
    v_mfma_f32_32x32x16_bf16 v[64:79], v[96:99], v[120:123], v[64:79]
    ds_read_b64_tr_b16 v[160:161], v184 offset:12544
    ds_read_b64_tr_b16 v[162:163], v184 offset:14080
    v_mfma_f32_32x32x16_bf16 v[80:95], v[100:103], v[120:123], v[80:95]
    ds_read_b64_tr_b16 v[164:165], v184 offset:18432
    ds_read_b64_tr_b16 v[166:167], v184 offset:19968
    v_mfma_f32_32x32x16_bf16 v[0:15], v[124:127], v[104:107], v[0:15]
    ds_read_b128 v[144:147], v179 offset:0
    ds_read_b128 v[148:151], v179 offset:4096
    v_mfma_f32_32x32x16_bf16 v[16:31], v[124:127], v[108:111], v[16:31]
    ds_read_b64_tr_b16 v[168:169], v184 offset:18560
    ds_read_b64_tr_b16 v[170:171], v184 offset:20096
    v_mfma_f32_32x32x16_bf16 v[32:47], v[128:131], v[104:107], v[32:47]
    ds_read_b64_tr_b16 v[172:173], v184 offset:18688
    ds_read_b64_tr_b16 v[174:175], v184 offset:20224
    v_mfma_f32_32x32x16_bf16 v[48:63], v[128:131], v[108:111], v[48:63]
    s_add_u32 s36, s29, 0
    s_cmp_lt_u32 s36, 2048
    s_cselect_b32 s37, s28, s34
    s_add_u32 s36, s36, s37
    s_add_u32 s36, s36, 262144
    s_add_u32 s37, s26, s31
    s_add_u32 m0, s37, 16384
    s_nop 0
    buffer_load_dwordx4 v236, s[4:7], s36 offen lds
    v_mfma_f32_32x32x16_bf16 v[64:79], v[104:107], v[132:135], v[64:79]
    buffer_load_dwordx4 v237, s[4:7], s36 offen offset:1024 lds
    v_mfma_f32_32x32x16_bf16 v[80:95], v[108:111], v[132:135], v[80:95]
    s_add_u32 s37, s32, s27
    s_add_u32 m0, s37, 0
    s_mov_b64 exec, s[40:41]
    buffer_load_dwordx4 v238, s[8:11], s30 offen lds
    buffer_load_dwordx4 v239, s[8:11], s30 offen offset:768 lds
    buffer_load_dword v255, v253, s[64:67], s72 offen
    s_add_u32 s72, s72, s73
    s_mov_b64 exec, -1
    s_add_u32 s30, s30, 196608
    s_waitcnt lgkmcnt(0)
    v_mfma_f32_32x32x16_bf16 v[0:15], v[152:155], v[136:139], v[0:15]
    v_mfma_f32_32x32x16_bf16 v[16:31], v[152:155], v[140:143], v[16:31]
    s_xor_b32 s38, s27, 24576
    v_add_u32 v176, s25, v180
    v_add_u32 v177, s25, v181
    v_add_u32 v178, s25, v182
    v_add_u32 v179, s25, v183
    v_add_u32 v184, s38, v185
    s_waitcnt vmcnt(10)
    s_barrier
    ds_read_b64_tr_b16 v[112:113], v184 offset:0
    ds_read_b64_tr_b16 v[114:115], v184 offset:1536
    v_mfma_f32_32x32x16_bf16 v[32:47], v[156:159], v[136:139], v[32:47]
    ds_read_b128 v[96:99], v176 offset:0
    ds_read_b128 v[100:103], v176 offset:4096
    v_mfma_f32_32x32x16_bf16 v[48:63], v[156:159], v[140:143], v[48:63]
    ds_read_b64_tr_b16 v[116:117], v184 offset:128
    ds_read_b64_tr_b16 v[118:119], v184 offset:1664
    v_mfma_f32_32x32x16_bf16 v[64:79], v[136:139], v[160:163], v[64:79]
    ds_read_b64_tr_b16 v[120:121], v184 offset:256
    ds_read_b64_tr_b16 v[122:123], v184 offset:1792
    v_mfma_f32_32x32x16_bf16 v[80:95], v[140:143], v[160:163], v[80:95]
    ds_read_b64_tr_b16 v[124:125], v184 offset:6144
    ds_read_b64_tr_b16 v[126:127], v184 offset:7680
    v_mfma_f32_32x32x16_bf16 v[0:15], v[164:167], v[144:147], v[0:15]
    ds_read_b128 v[104:107], v177 offset:0
    ds_read_b128 v[108:111], v177 offset:4096
    v_mfma_f32_32x32x16_bf16 v[16:31], v[164:167], v[148:151], v[16:31]
    ds_read_b64_tr_b16 v[128:129], v184 offset:6272
    ds_read_b64_tr_b16 v[130:131], v184 offset:7808
    v_mfma_f32_32x32x16_bf16 v[32:47], v[168:171], v[144:147], v[32:47]
    ds_read_b64_tr_b16 v[132:133], v184 offset:6400
    ds_read_b64_tr_b16 v[134:135], v184 offset:7936
    v_mfma_f32_32x32x16_bf16 v[48:63], v[168:171], v[148:151], v[48:63]
    s_add_u32 s36, s29, 128
    s_cmp_lt_u32 s36, 2048
    s_cselect_b32 s37, s28, s34
    s_add_u32 s36, s36, s37
    s_add_u32 s37, s24, s31
    s_add_u32 m0, s37, 0
    s_nop 0
    buffer_load_dwordx4 v236, s[4:7], s36 offen lds
    v_mfma_f32_32x32x16_bf16 v[64:79], v[144:147], v[172:175], v[64:79]
    buffer_load_dwordx4 v237, s[4:7], s36 offen offset:1024 lds
    v_mfma_f32_32x32x16_bf16 v[80:95], v[148:151], v[172:175], v[80:95]
    s_add_u32 s37, s32, s27
    s_add_u32 m0, s37, 12288
    s_mov_b64 exec, s[40:41]
    buffer_load_dwordx4 v238, s[8:11], s30 offen lds
    buffer_load_dwordx4 v239, s[8:11], s30 offen offset:768 lds
    buffer_load_dword v255, v253, s[64:67], s72 offen
    s_add_u32 s72, s72, s73
    s_mov_b64 exec, -1
    s_add_u32 s30, s30, 196608
    s_cmp_lg_u32 s33, 11
    s_cbranch_scc1 .Lk2_att_nosw
    s_mov_b32 s64, s68
    s_mov_b32 s65, s69
    s_mov_b32 s66, s70
    s_mov_b32 s72, 0
    s_mov_b32 s73, s74
    v_mov_b32 v253, v254
.Lk2_att_nosw:
    s_cmp_lg_u32 s33, 3
    s_cbranch_scc1 .Lk2_att_nocp
    s_getpc_b64 s[88:89]
.Lpc_att:
    s_add_u32 s88, s88, .Lmid0-.Lpc_att
    s_addc_u32 s89, s89, -1
    v_lshlrev_b32 v242, 6, v240
    v_lshl_add_u32 v242, s3, 12, v242
    v_min_u32 v242, .Lk4_end-.Lmid0, v242
    v_mov_b32 v243, s89
    v_add_co_u32 v242, vcc, s88, v242
    s_nop 1
    v_addc_co_u32 v243, vcc, 0, v243, vcc
    global_load_dword v255, v[242:243], off
.Lk2_att_nocp:
    s_xor_b32 s27, s27, 24576
    s_mov_b32 s36, s24
    s_mov_b32 s24, s25
    s_mov_b32 s25, s26
    s_mov_b32 s26, s36
    s_add_u32 s29, s29, 128
    s_sub_u32 s33, s33, 1
    s_cmp_lg_u32 s33, 0
    s_cbranch_scc1 .Lk2_att_loop
    s_mov_b32 s48, 0x3fb8aa3b
    s_waitcnt vmcnt(0) lgkmcnt(0)
    s_barrier
    v_lshrrev_b32 v245, 5, v240
    v_bfe_u32 v246, v240, 2, 2
    v_lshl_add_u32 v246, v245, 2, v246
    v_lshlrev_b32 v246, 6, v246
    v_bfe_u32 v247, v240, 4, 1
    v_lshl_add_u32 v246, v247, 5, v246
    v_and_b32 v247, 3, v240
    v_lshl_add_u32 v246, v247, 3, v246
    s_lshl_b32 s36, s23, 11
    s_add_u32 s36, s36, 147456
    v_add_u32 v246, s36, v246
    ds_read_b64_tr_b16 v[186:187], v246 offset:0
    ds_read_b64_tr_b16 v[188:189], v246 offset:512
    ds_read_b64_tr_b16 v[190:191], v246 offset:1024
    ds_read_b64_tr_b16 v[192:193], v246 offset:1536
    v_and_b32 v247, 31, v240
    v_lshlrev_b32 v245, 2, v245
    v_sub_u32 v247, v247, v245
    v_mov_b32 v245, 0x3f80
    v_mov_b32 v248, 0x3f800000
    v_cmp_eq_u32 vcc, 0, v247
    s_nop 1
    v_cndmask_b32 v194, 0, v245, vcc
    v_cmp_eq_u32 vcc, 1, v247
    s_nop 1
    v_cndmask_b32 v194, v194, v248, vcc
    v_cmp_eq_u32 vcc, 2, v247
    s_nop 1
    v_cndmask_b32 v195, 0, v245, vcc
    v_cmp_eq_u32 vcc, 3, v247
    s_nop 1
    v_cndmask_b32 v195, v195, v248, vcc
    v_cmp_eq_u32 vcc, 8, v247
    s_nop 1
    v_cndmask_b32 v196, 0, v245, vcc
    v_cmp_eq_u32 vcc, 9, v247
    s_nop 1
    v_cndmask_b32 v196, v196, v248, vcc
    v_cmp_eq_u32 vcc, 10, v247
    s_nop 1
    v_cndmask_b32 v197, 0, v245, vcc
    v_cmp_eq_u32 vcc, 11, v247
    s_nop 1
    v_cndmask_b32 v197, v197, v248, vcc
    v_cmp_eq_u32 vcc, 16, v247
    s_nop 1
    v_cndmask_b32 v198, 0, v245, vcc
    v_cmp_eq_u32 vcc, 17, v247
    s_nop 1
    v_cndmask_b32 v198, v198, v248, vcc
    v_cmp_eq_u32 vcc, 18, v247
    s_nop 1
    v_cndmask_b32 v199, 0, v245, vcc
    v_cmp_eq_u32 vcc, 19, v247
    s_nop 1
    v_cndmask_b32 v199, v199, v248, vcc
    v_cmp_eq_u32 vcc, 24, v247
    s_nop 1
    v_cndmask_b32 v200, 0, v245, vcc
    v_cmp_eq_u32 vcc, 25, v247
    s_nop 1
    v_cndmask_b32 v200, v200, v248, vcc
    v_cmp_eq_u32 vcc, 26, v247
    s_nop 1
    v_cndmask_b32 v201, 0, v245, vcc
    v_cmp_eq_u32 vcc, 27, v247
    s_nop 1
    v_cndmask_b32 v201, v201, v248, vcc
    v_mov_b32 v202, 0x3f803f80
    v_mov_b32 v203, 0x3f803f80
    v_mov_b32 v204, 0x3f803f80
    v_mov_b32 v205, 0x3f803f80
    s_waitcnt lgkmcnt(0)
    v_cvt_pk_bf16_f32 v64, v64, v65
    v_cvt_pk_bf16_f32 v65, v66, v67
    v_cvt_pk_bf16_f32 v66, v68, v69
    v_cvt_pk_bf16_f32 v67, v70, v71
    v_cvt_pk_bf16_f32 v68, v72, v73
    v_cvt_pk_bf16_f32 v69, v74, v75
    v_cvt_pk_bf16_f32 v70, v76, v77
    v_cvt_pk_bf16_f32 v71, v78, v79
    v_cvt_pk_bf16_f32 v80, v80, v81
    v_cvt_pk_bf16_f32 v81, v82, v83
    v_cvt_pk_bf16_f32 v82, v84, v85
    v_cvt_pk_bf16_f32 v83, v86, v87
    v_cvt_pk_bf16_f32 v84, v88, v89
    v_cvt_pk_bf16_f32 v85, v90, v91
    v_cvt_pk_bf16_f32 v86, v92, v93
    v_cvt_pk_bf16_f32 v87, v94, v95
    v_cvt_pk_bf16_f32 v32, v32, v33
    v_cvt_pk_bf16_f32 v33, v34, v35
    v_cvt_pk_bf16_f32 v34, v36, v37
    v_cvt_pk_bf16_f32 v35, v38, v39
    v_cvt_pk_bf16_f32 v36, v40, v41
    v_cvt_pk_bf16_f32 v37, v42, v43
    v_cvt_pk_bf16_f32 v38, v44, v45
    v_cvt_pk_bf16_f32 v39, v46, v47
    s_nop 1
    v_mfma_f32_32x32x16_bf16 v[160:175], v[186:189], v[32:35], 0
    v_mfma_f32_32x32x16_bf16 v[160:175], v[190:193], v[36:39], v[160:175]
    s_nop 15
    s_nop 3
    v_max3_f32 v241, v160, v161, v162
    v_min3_f32 v242, v160, v161, v162
    v_max3_f32 v241, v241, v163, v164
    v_min3_f32 v242, v242, v163, v164
    v_max3_f32 v241, v241, v165, v166
    v_min3_f32 v242, v242, v165, v166
    v_max3_f32 v241, v241, v167, v168
    v_min3_f32 v242, v242, v167, v168
    v_max3_f32 v241, v241, v169, v170
    v_min3_f32 v242, v242, v169, v170
    v_max3_f32 v241, v241, v171, v172
    v_min3_f32 v242, v242, v171, v172
    v_max3_f32 v241, v241, v173, v174
    v_min3_f32 v242, v242, v173, v174
    v_max_f32 v241, v241, v175
    v_min_f32 v242, v242, v175
    v_mov_b32 v245, v241
    v_mov_b32 v246, v242
    s_nop 1
    v_permlane32_swap_b32 v241, v245
    v_permlane32_swap_b32 v242, v246
    s_nop 1
    v_max_f32 v241, v241, v245
    v_min_f32 v242, v242, v246
    v_mul_f32 v241, s48, v241
    v_mul_f32 v242, s48, v242
    v_fma_f32 v206, v160, s48, -v241
    v_fma_f32 v222, -v160, s48, v242
    v_fma_f32 v207, v161, s48, -v241
    v_fma_f32 v223, -v161, s48, v242
    v_fma_f32 v208, v162, s48, -v241
    v_fma_f32 v224, -v162, s48, v242
    v_fma_f32 v209, v163, s48, -v241
    v_fma_f32 v225, -v163, s48, v242
    v_fma_f32 v210, v164, s48, -v241
    v_fma_f32 v226, -v164, s48, v242
    v_fma_f32 v211, v165, s48, -v241
    v_fma_f32 v227, -v165, s48, v242
    v_fma_f32 v212, v166, s48, -v241
    v_fma_f32 v228, -v166, s48, v242
    v_fma_f32 v213, v167, s48, -v241
    v_fma_f32 v229, -v167, s48, v242
    v_fma_f32 v214, v168, s48, -v241
    v_fma_f32 v230, -v168, s48, v242
    v_fma_f32 v215, v169, s48, -v241
    v_fma_f32 v231, -v169, s48, v242
    v_fma_f32 v216, v170, s48, -v241
    v_fma_f32 v232, -v170, s48, v242
    v_fma_f32 v217, v171, s48, -v241
    v_fma_f32 v233, -v171, s48, v242
    v_fma_f32 v218, v172, s48, -v241
    v_fma_f32 v234, -v172, s48, v242
    v_fma_f32 v219, v173, s48, -v241
    v_fma_f32 v235, -v173, s48, v242
    v_fma_f32 v220, v174, s48, -v241
    v_fma_f32 v236, -v174, s48, v242
    v_fma_f32 v221, v175, s48, -v241
    v_fma_f32 v237, -v175, s48, v242
    v_exp_f32 v206, v206
    v_exp_f32 v222, v222
    v_exp_f32 v207, v207
    v_exp_f32 v223, v223
    v_exp_f32 v208, v208
    v_exp_f32 v224, v224
    v_exp_f32 v209, v209
    v_exp_f32 v225, v225
    v_exp_f32 v210, v210
    v_exp_f32 v226, v226
    v_exp_f32 v211, v211
    v_exp_f32 v227, v227
    v_exp_f32 v212, v212
    v_exp_f32 v228, v228
    v_exp_f32 v213, v213
    v_exp_f32 v229, v229
    v_exp_f32 v214, v214
    v_exp_f32 v230, v230
    v_exp_f32 v215, v215
    v_exp_f32 v231, v231
    v_exp_f32 v216, v216
    v_exp_f32 v232, v232
    v_exp_f32 v217, v217
    v_exp_f32 v233, v233
    v_exp_f32 v218, v218
    v_exp_f32 v234, v234
    v_exp_f32 v219, v219
    v_exp_f32 v235, v235
    v_exp_f32 v220, v220
    v_exp_f32 v236, v236
    v_exp_f32 v221, v221
    v_exp_f32 v237, v237
    v_add_f32 v243, v206, v207
    v_add_f32 v244, v222, v223
    v_add_f32 v245, v208, v209
    v_add_f32 v246, v224, v225
    v_add_f32 v243, v243, v210
    v_add_f32 v244, v244, v226
    v_add_f32 v245, v245, v211
    v_add_f32 v246, v246, v227
    v_add_f32 v243, v243, v212
    v_add_f32 v244, v244, v228
    v_add_f32 v245, v245, v213
    v_add_f32 v246, v246, v229
    v_add_f32 v243, v243, v214
    v_add_f32 v244, v244, v230
    v_add_f32 v245, v245, v215
    v_add_f32 v246, v246, v231
    v_add_f32 v243, v243, v216
    v_add_f32 v244, v244, v232
    v_add_f32 v245, v245, v217
    v_add_f32 v246, v246, v233
    v_add_f32 v243, v243, v218
    v_add_f32 v244, v244, v234
    v_add_f32 v245, v245, v219
    v_add_f32 v246, v246, v235
    v_add_f32 v243, v243, v220
    v_add_f32 v244, v244, v236
    v_add_f32 v245, v245, v221
    v_add_f32 v246, v246, v237
    v_add_f32 v243, v243, v245
    v_add_f32 v244, v244, v246
    v_mov_b32 v245, v243
    v_mov_b32 v246, v244
    s_nop 1
    v_permlane32_swap_b32 v243, v245
    v_permlane32_swap_b32 v244, v246
    s_nop 1
    v_add_f32 v243, v243, v245
    v_add_f32 v244, v244, v246
    v_rcp_f32 v243, v243
    v_rcp_f32 v244, v244
    s_nop 0
    v_mul_f32 v206, v206, v243
    v_mul_f32 v222, v222, v244
    v_mul_f32 v207, v207, v243
    v_mul_f32 v223, v223, v244
    v_mul_f32 v208, v208, v243
    v_mul_f32 v224, v224, v244
    v_mul_f32 v209, v209, v243
    v_mul_f32 v225, v225, v244
    v_mul_f32 v210, v210, v243
    v_mul_f32 v226, v226, v244
    v_mul_f32 v211, v211, v243
    v_mul_f32 v227, v227, v244
    v_mul_f32 v212, v212, v243
    v_mul_f32 v228, v228, v244
    v_mul_f32 v213, v213, v243
    v_mul_f32 v229, v229, v244
    v_mul_f32 v214, v214, v243
    v_mul_f32 v230, v230, v244
    v_mul_f32 v215, v215, v243
    v_mul_f32 v231, v231, v244
    v_mul_f32 v216, v216, v243
    v_mul_f32 v232, v232, v244
    v_mul_f32 v217, v217, v243
    v_mul_f32 v233, v233, v244
    v_mul_f32 v218, v218, v243
    v_mul_f32 v234, v234, v244
    v_mul_f32 v219, v219, v243
    v_mul_f32 v235, v235, v244
    v_mul_f32 v220, v220, v243
    v_mul_f32 v236, v236, v244
    v_mul_f32 v221, v221, v243
    v_mul_f32 v237, v237, v244
    v_cvt_pk_bf16_f32 v32, v206, v207
    v_cvt_pk_bf16_f32 v33, v208, v209
    v_cvt_pk_bf16_f32 v34, v210, v211
    v_cvt_pk_bf16_f32 v35, v212, v213
    v_cvt_pk_bf16_f32 v36, v214, v215
    v_cvt_pk_bf16_f32 v37, v216, v217
    v_cvt_pk_bf16_f32 v38, v218, v219
    v_cvt_pk_bf16_f32 v39, v220, v221
    v_cvt_pk_bf16_f32 v40, v222, v223
    v_cvt_pk_bf16_f32 v41, v224, v225
    v_cvt_pk_bf16_f32 v42, v226, v227
    v_cvt_pk_bf16_f32 v43, v228, v229
    v_cvt_pk_bf16_f32 v44, v230, v231
    v_cvt_pk_bf16_f32 v45, v232, v233
    v_cvt_pk_bf16_f32 v46, v234, v235
    v_cvt_pk_bf16_f32 v47, v236, v237
    s_nop 1
    v_mfma_f32_32x32x16_bf16 v[160:175], v[32:35], v[194:197], 0
    v_mfma_f32_32x32x16_bf16 v[160:175], v[36:39], v[198:201], v[160:175]
    s_nop 15
    s_nop 3
    v_cvt_pk_bf16_f32 v206, v160, v161
    v_cvt_pk_bf16_f32 v207, v162, v163
    v_cvt_pk_bf16_f32 v208, v164, v165
    v_cvt_pk_bf16_f32 v209, v166, v167
    v_cvt_pk_bf16_f32 v210, v168, v169
    v_cvt_pk_bf16_f32 v211, v170, v171
    v_cvt_pk_bf16_f32 v212, v172, v173
    v_cvt_pk_bf16_f32 v213, v174, v175
    s_nop 1
    v_mfma_f32_32x32x16_bf16 v[96:111], v[206:209], v[64:67], 0
    v_mfma_f32_32x32x16_bf16 v[128:143], v[202:205], v[206:209], 0
    v_mfma_f32_32x32x16_bf16 v[96:111], v[210:213], v[68:71], v[96:111]
    v_mfma_f32_32x32x16_bf16 v[128:143], v[202:205], v[210:213], v[128:143]
    s_nop 7
    s_nop 1
    v_mfma_f32_32x32x16_bf16 v[160:175], v[40:43], v[194:197], 0
    v_mfma_f32_32x32x16_bf16 v[160:175], v[44:47], v[198:201], v[160:175]
    s_nop 15
    s_nop 3
    v_cvt_pk_bf16_f32 v206, v160, v161
    v_cvt_pk_bf16_f32 v207, v162, v163
    v_cvt_pk_bf16_f32 v208, v164, v165
    v_cvt_pk_bf16_f32 v209, v166, v167
    v_cvt_pk_bf16_f32 v210, v168, v169
    v_cvt_pk_bf16_f32 v211, v170, v171
    v_cvt_pk_bf16_f32 v212, v172, v173
    v_cvt_pk_bf16_f32 v213, v174, v175
    s_nop 1
    v_mfma_f32_32x32x16_bf16 v[112:127], v[206:209], v[64:67], 0
    v_mfma_f32_32x32x16_bf16 v[144:159], v[202:205], v[206:209], 0
    v_mfma_f32_32x32x16_bf16 v[112:127], v[210:213], v[68:71], v[112:127]
    v_mfma_f32_32x32x16_bf16 v[144:159], v[202:205], v[210:213], v[144:159]
    s_nop 7
    v_cvt_pk_bf16_f32 v48, v48, v49
    v_cvt_pk_bf16_f32 v49, v50, v51
    v_cvt_pk_bf16_f32 v50, v52, v53
    v_cvt_pk_bf16_f32 v51, v54, v55
    v_cvt_pk_bf16_f32 v52, v56, v57
    v_cvt_pk_bf16_f32 v53, v58, v59
    v_cvt_pk_bf16_f32 v54, v60, v61
    v_cvt_pk_bf16_f32 v55, v62, v63
    s_nop 1
    v_mfma_f32_32x32x16_bf16 v[160:175], v[186:189], v[48:51], 0
    v_mfma_f32_32x32x16_bf16 v[160:175], v[190:193], v[52:55], v[160:175]
    s_nop 15
    s_nop 3
    v_max3_f32 v241, v160, v161, v162
    v_min3_f32 v242, v160, v161, v162
    v_max3_f32 v241, v241, v163, v164
    v_min3_f32 v242, v242, v163, v164
    v_max3_f32 v241, v241, v165, v166
    v_min3_f32 v242, v242, v165, v166
    v_max3_f32 v241, v241, v167, v168
    v_min3_f32 v242, v242, v167, v168
    v_max3_f32 v241, v241, v169, v170
    v_min3_f32 v242, v242, v169, v170
    v_max3_f32 v241, v241, v171, v172
    v_min3_f32 v242, v242, v171, v172
    v_max3_f32 v241, v241, v173, v174
    v_min3_f32 v242, v242, v173, v174
    v_max_f32 v241, v241, v175
    v_min_f32 v242, v242, v175
    v_mov_b32 v245, v241
    v_mov_b32 v246, v242
    s_nop 1
    v_permlane32_swap_b32 v241, v245
    v_permlane32_swap_b32 v242, v246
    s_nop 1
    v_max_f32 v241, v241, v245
    v_min_f32 v242, v242, v246
    v_mul_f32 v241, s48, v241
    v_mul_f32 v242, s48, v242
    v_fma_f32 v206, v160, s48, -v241
    v_fma_f32 v222, -v160, s48, v242
    v_fma_f32 v207, v161, s48, -v241
    v_fma_f32 v223, -v161, s48, v242
    v_fma_f32 v208, v162, s48, -v241
    v_fma_f32 v224, -v162, s48, v242
    v_fma_f32 v209, v163, s48, -v241
    v_fma_f32 v225, -v163, s48, v242
    v_fma_f32 v210, v164, s48, -v241
    v_fma_f32 v226, -v164, s48, v242
    v_fma_f32 v211, v165, s48, -v241
    v_fma_f32 v227, -v165, s48, v242
    v_fma_f32 v212, v166, s48, -v241
    v_fma_f32 v228, -v166, s48, v242
    v_fma_f32 v213, v167, s48, -v241
    v_fma_f32 v229, -v167, s48, v242
    v_fma_f32 v214, v168, s48, -v241
    v_fma_f32 v230, -v168, s48, v242
    v_fma_f32 v215, v169, s48, -v241
    v_fma_f32 v231, -v169, s48, v242
    v_fma_f32 v216, v170, s48, -v241
    v_fma_f32 v232, -v170, s48, v242
    v_fma_f32 v217, v171, s48, -v241
    v_fma_f32 v233, -v171, s48, v242
    v_fma_f32 v218, v172, s48, -v241
    v_fma_f32 v234, -v172, s48, v242
    v_fma_f32 v219, v173, s48, -v241
    v_fma_f32 v235, -v173, s48, v242
    v_fma_f32 v220, v174, s48, -v241
    v_fma_f32 v236, -v174, s48, v242
    v_fma_f32 v221, v175, s48, -v241
    v_fma_f32 v237, -v175, s48, v242
    v_exp_f32 v206, v206
    v_exp_f32 v222, v222
    v_exp_f32 v207, v207
    v_exp_f32 v223, v223
    v_exp_f32 v208, v208
    v_exp_f32 v224, v224
    v_exp_f32 v209, v209
    v_exp_f32 v225, v225
    v_exp_f32 v210, v210
    v_exp_f32 v226, v226
    v_exp_f32 v211, v211
    v_exp_f32 v227, v227
    v_exp_f32 v212, v212
    v_exp_f32 v228, v228
    v_exp_f32 v213, v213
    v_exp_f32 v229, v229
    v_exp_f32 v214, v214
    v_exp_f32 v230, v230
    v_exp_f32 v215, v215
    v_exp_f32 v231, v231
    v_exp_f32 v216, v216
    v_exp_f32 v232, v232
    v_exp_f32 v217, v217
    v_exp_f32 v233, v233
    v_exp_f32 v218, v218
    v_exp_f32 v234, v234
    v_exp_f32 v219, v219
    v_exp_f32 v235, v235
    v_exp_f32 v220, v220
    v_exp_f32 v236, v236
    v_exp_f32 v221, v221
    v_exp_f32 v237, v237
    v_add_f32 v243, v206, v207
    v_add_f32 v244, v222, v223
    v_add_f32 v245, v208, v209
    v_add_f32 v246, v224, v225
    v_add_f32 v243, v243, v210
    v_add_f32 v244, v244, v226
    v_add_f32 v245, v245, v211
    v_add_f32 v246, v246, v227
    v_add_f32 v243, v243, v212
    v_add_f32 v244, v244, v228
    v_add_f32 v245, v245, v213
    v_add_f32 v246, v246, v229
    v_add_f32 v243, v243, v214
    v_add_f32 v244, v244, v230
    v_add_f32 v245, v245, v215
    v_add_f32 v246, v246, v231
    v_add_f32 v243, v243, v216
    v_add_f32 v244, v244, v232
    v_add_f32 v245, v245, v217
    v_add_f32 v246, v246, v233
    v_add_f32 v243, v243, v218
    v_add_f32 v244, v244, v234
    v_add_f32 v245, v245, v219
    v_add_f32 v246, v246, v235
    v_add_f32 v243, v243, v220
    v_add_f32 v244, v244, v236
    v_add_f32 v245, v245, v221
    v_add_f32 v246, v246, v237
    v_add_f32 v243, v243, v245
    v_add_f32 v244, v244, v246
    v_mov_b32 v245, v243
    v_mov_b32 v246, v244
    s_nop 1
    v_permlane32_swap_b32 v243, v245
    v_permlane32_swap_b32 v244, v246
    s_nop 1
    v_add_f32 v243, v243, v245
    v_add_f32 v244, v244, v246
    v_rcp_f32 v243, v243
    v_rcp_f32 v244, v244
    s_nop 0
    v_mul_f32 v206, v206, v243
    v_mul_f32 v222, v222, v244
    v_mul_f32 v207, v207, v243
    v_mul_f32 v223, v223, v244
    v_mul_f32 v208, v208, v243
    v_mul_f32 v224, v224, v244
    v_mul_f32 v209, v209, v243
    v_mul_f32 v225, v225, v244
    v_mul_f32 v210, v210, v243
    v_mul_f32 v226, v226, v244
    v_mul_f32 v211, v211, v243
    v_mul_f32 v227, v227, v244
    v_mul_f32 v212, v212, v243
    v_mul_f32 v228, v228, v244
    v_mul_f32 v213, v213, v243
    v_mul_f32 v229, v229, v244
    v_mul_f32 v214, v214, v243
    v_mul_f32 v230, v230, v244
    v_mul_f32 v215, v215, v243
    v_mul_f32 v231, v231, v244
    v_mul_f32 v216, v216, v243
    v_mul_f32 v232, v232, v244
    v_mul_f32 v217, v217, v243
    v_mul_f32 v233, v233, v244
    v_mul_f32 v218, v218, v243
    v_mul_f32 v234, v234, v244
    v_mul_f32 v219, v219, v243
    v_mul_f32 v235, v235, v244
    v_mul_f32 v220, v220, v243
    v_mul_f32 v236, v236, v244
    v_mul_f32 v221, v221, v243
    v_mul_f32 v237, v237, v244
    v_cvt_pk_bf16_f32 v48, v206, v207
    v_cvt_pk_bf16_f32 v49, v208, v209
    v_cvt_pk_bf16_f32 v50, v210, v211
    v_cvt_pk_bf16_f32 v51, v212, v213
    v_cvt_pk_bf16_f32 v52, v214, v215
    v_cvt_pk_bf16_f32 v53, v216, v217
    v_cvt_pk_bf16_f32 v54, v218, v219
    v_cvt_pk_bf16_f32 v55, v220, v221
    v_cvt_pk_bf16_f32 v56, v222, v223
    v_cvt_pk_bf16_f32 v57, v224, v225
    v_cvt_pk_bf16_f32 v58, v226, v227
    v_cvt_pk_bf16_f32 v59, v228, v229
    v_cvt_pk_bf16_f32 v60, v230, v231
    v_cvt_pk_bf16_f32 v61, v232, v233
    v_cvt_pk_bf16_f32 v62, v234, v235
    v_cvt_pk_bf16_f32 v63, v236, v237
    s_nop 1
    v_mfma_f32_32x32x16_bf16 v[160:175], v[48:51], v[194:197], 0
    v_mfma_f32_32x32x16_bf16 v[160:175], v[52:55], v[198:201], v[160:175]
    s_nop 15
    s_nop 3
    v_cvt_pk_bf16_f32 v206, v160, v161
    v_cvt_pk_bf16_f32 v207, v162, v163
    v_cvt_pk_bf16_f32 v208, v164, v165
    v_cvt_pk_bf16_f32 v209, v166, v167
    v_cvt_pk_bf16_f32 v210, v168, v169
    v_cvt_pk_bf16_f32 v211, v170, v171
    v_cvt_pk_bf16_f32 v212, v172, v173
    v_cvt_pk_bf16_f32 v213, v174, v175
    s_nop 1
    v_mfma_f32_32x32x16_bf16 v[96:111], v[206:209], v[80:83], v[96:111]
    v_mfma_f32_32x32x16_bf16 v[128:143], v[202:205], v[206:209], v[128:143]
    v_mfma_f32_32x32x16_bf16 v[96:111], v[210:213], v[84:87], v[96:111]
    v_mfma_f32_32x32x16_bf16 v[128:143], v[202:205], v[210:213], v[128:143]
    s_nop 7
    s_nop 1
    v_mfma_f32_32x32x16_bf16 v[160:175], v[56:59], v[194:197], 0
    v_mfma_f32_32x32x16_bf16 v[160:175], v[60:63], v[198:201], v[160:175]
    s_nop 15
    s_nop 3
    v_cvt_pk_bf16_f32 v206, v160, v161
    v_cvt_pk_bf16_f32 v207, v162, v163
    v_cvt_pk_bf16_f32 v208, v164, v165
    v_cvt_pk_bf16_f32 v209, v166, v167
    v_cvt_pk_bf16_f32 v210, v168, v169
    v_cvt_pk_bf16_f32 v211, v170, v171
    v_cvt_pk_bf16_f32 v212, v172, v173
    v_cvt_pk_bf16_f32 v213, v174, v175
    s_nop 1
    v_mfma_f32_32x32x16_bf16 v[112:127], v[206:209], v[80:83], v[112:127]
    v_mfma_f32_32x32x16_bf16 v[144:159], v[202:205], v[206:209], v[144:159]
    v_mfma_f32_32x32x16_bf16 v[112:127], v[210:213], v[84:87], v[112:127]
    v_mfma_f32_32x32x16_bf16 v[144:159], v[202:205], v[210:213], v[144:159]
    s_nop 7
    s_nop 15
    s_nop 3
    s_lshl_b32 s36, s3, 13
    v_lshlrev_b32 v246, 4, v240
    v_add_u32 v245, s36, v246
    v_cmp_gt_u32 vcc, 32, v240
    s_nop 1
    v_cndmask_b32 v247, v144, v128, vcc
    s_lshl_b32 s36, s3, 8
    s_add_u32 s36, s36, 65536
    v_lshlrev_b32 v248, 2, v240
    v_add_u32 v249, s36, v248
    ds_write_b128 v245, v[96:99] offset:0
    ds_write_b128 v245, v[100:103] offset:1024
    ds_write_b128 v245, v[104:107] offset:2048
    ds_write_b128 v245, v[108:111] offset:3072
    ds_write_b128 v245, v[112:115] offset:4096
    ds_write_b128 v245, v[116:119] offset:5120
    ds_write_b128 v245, v[120:123] offset:6144
    ds_write_b128 v245, v[124:127] offset:7168
    ds_write_b32 v249, v247
    s_lshl_b32 s36, s23, 15
    s_lshl_b32 s37, s22, 11
    s_add_u32 s36, s36, s37
    v_add_u32 v245, s36, v246
    s_lshl_b32 s36, s23, 10
    s_add_u32 s36, s36, 65536
    v_add_u32 v249, s36, v248
    s_waitcnt lgkmcnt(0)
    s_barrier
    ds_read_b128 v[96:99], v245 offset:0
    ds_read_b128 v[100:103], v245 offset:1024
    ds_read_b128 v[104:107], v245 offset:8192
    ds_read_b128 v[108:111], v245 offset:9216
    ds_read_b128 v[112:115], v245 offset:16384
    ds_read_b128 v[116:119], v245 offset:17408
    ds_read_b128 v[120:123], v245 offset:24576
    ds_read_b128 v[124:127], v245 offset:25600
    ds_read_b32 v128, v249 offset:0
    ds_read_b32 v129, v249 offset:256
    ds_read_b32 v130, v249 offset:512
    ds_read_b32 v131, v249 offset:768
    s_lshl_b32 s52, s21, 1
    s_add_u32 s52, s52, s23
    s_lshl_b32 s36, s52, 3
    s_add_u32 s36, s36, s20
    s_lshl_b32 s51, s36, 8
    s_add_u32 s51, s51, 0x02400000
    s_lshl_b32 s50, s36, 13
    s_lshl_b32 s37, s22, 11
    s_add_u32 s50, s50, s37
    s_add_u32 s50, s50, 0x02000000
    s_waitcnt lgkmcnt(0)
    v_add_f32 v96, v96, v104
    v_add_f32 v112, v112, v120
    v_add_f32 v97, v97, v105
    v_add_f32 v113, v113, v121
    v_add_f32 v98, v98, v106
    v_add_f32 v114, v114, v122
    v_add_f32 v99, v99, v107
    v_add_f32 v115, v115, v123
    v_add_f32 v100, v100, v108
    v_add_f32 v116, v116, v124
    v_add_f32 v101, v101, v109
    v_add_f32 v117, v117, v125
    v_add_f32 v102, v102, v110
    v_add_f32 v118, v118, v126
    v_add_f32 v103, v103, v111
    v_add_f32 v119, v119, v127
    v_add_f32 v128, v128, v129
    v_add_f32 v130, v130, v131
    v_add_f32 v96, v96, v112
    v_add_f32 v97, v97, v113
    v_add_f32 v98, v98, v114
    v_add_f32 v99, v99, v115
    v_add_f32 v100, v100, v116
    v_add_f32 v101, v101, v117
    v_add_f32 v102, v102, v118
    v_add_f32 v103, v103, v119
    v_add_f32 v128, v128, v130
    v_mov_b32 v238, v246
    v_mov_b32 v239, v248
    buffer_store_dwordx4 v[96:99], v238, s[12:15], s50 offen offset:0 sc1
    buffer_store_dwordx4 v[100:103], v238, s[12:15], s50 offen offset:1024 sc1
    s_cmp_lg_u32 s22, 0
    s_cbranch_scc1 .Lk2_noz
    buffer_store_dword v128, v239, s[12:15], s51 offen sc1
.Lk2_noz:
    v_cvt_pk_bf16_f32 v0, v0, v1
    v_cvt_pk_bf16_f32 v1, v2, v3
    v_cvt_pk_bf16_f32 v2, v4, v5
    v_cvt_pk_bf16_f32 v3, v6, v7
    v_cvt_pk_bf16_f32 v4, v8, v9
    v_cvt_pk_bf16_f32 v5, v10, v11
    v_cvt_pk_bf16_f32 v6, v12, v13
    v_cvt_pk_bf16_f32 v7, v14, v15
    s_nop 1
    v_mfma_f32_32x32x16_bf16 v[160:175], v[186:189], v[0:3], 0
    v_mfma_f32_32x32x16_bf16 v[160:175], v[190:193], v[4:7], v[160:175]
    s_nop 15
    s_nop 3
    v_max3_f32 v241, v160, v161, v162
    v_min3_f32 v242, v160, v161, v162
    v_max3_f32 v241, v241, v163, v164
    v_min3_f32 v242, v242, v163, v164
    v_max3_f32 v241, v241, v165, v166
    v_min3_f32 v242, v242, v165, v166
    v_max3_f32 v241, v241, v167, v168
    v_min3_f32 v242, v242, v167, v168
    v_max3_f32 v241, v241, v169, v170
    v_min3_f32 v242, v242, v169, v170
    v_max3_f32 v241, v241, v171, v172
    v_min3_f32 v242, v242, v171, v172
    v_max3_f32 v241, v241, v173, v174
    v_min3_f32 v242, v242, v173, v174
    v_max_f32 v241, v241, v175
    v_min_f32 v242, v242, v175
    v_mov_b32 v245, v241
    v_mov_b32 v246, v242
    s_nop 1
    v_permlane32_swap_b32 v241, v245
    v_permlane32_swap_b32 v242, v246
    s_nop 1
    v_max_f32 v241, v241, v245
    v_min_f32 v242, v242, v246
    v_mul_f32 v241, s48, v241
    v_mul_f32 v242, s48, v242
    v_fma_f32 v206, v160, s48, -v241
    v_fma_f32 v222, -v160, s48, v242
    v_fma_f32 v207, v161, s48, -v241
    v_fma_f32 v223, -v161, s48, v242
    v_fma_f32 v208, v162, s48, -v241
    v_fma_f32 v224, -v162, s48, v242
    v_fma_f32 v209, v163, s48, -v241
    v_fma_f32 v225, -v163, s48, v242
    v_fma_f32 v210, v164, s48, -v241
    v_fma_f32 v226, -v164, s48, v242
    v_fma_f32 v211, v165, s48, -v241
    v_fma_f32 v227, -v165, s48, v242
    v_fma_f32 v212, v166, s48, -v241
    v_fma_f32 v228, -v166, s48, v242
    v_fma_f32 v213, v167, s48, -v241
    v_fma_f32 v229, -v167, s48, v242
    v_fma_f32 v214, v168, s48, -v241
    v_fma_f32 v230, -v168, s48, v242
    v_fma_f32 v215, v169, s48, -v241
    v_fma_f32 v231, -v169, s48, v242
    v_fma_f32 v216, v170, s48, -v241
    v_fma_f32 v232, -v170, s48, v242
    v_fma_f32 v217, v171, s48, -v241
    v_fma_f32 v233, -v171, s48, v242
    v_fma_f32 v218, v172, s48, -v241
    v_fma_f32 v234, -v172, s48, v242
    v_fma_f32 v219, v173, s48, -v241
    v_fma_f32 v235, -v173, s48, v242
    v_fma_f32 v220, v174, s48, -v241
    v_fma_f32 v236, -v174, s48, v242
    v_fma_f32 v221, v175, s48, -v241
    v_fma_f32 v237, -v175, s48, v242
    v_exp_f32 v206, v206
    v_exp_f32 v222, v222
    v_exp_f32 v207, v207
    v_exp_f32 v223, v223
    v_exp_f32 v208, v208
    v_exp_f32 v224, v224
    v_exp_f32 v209, v209
    v_exp_f32 v225, v225
    v_exp_f32 v210, v210
    v_exp_f32 v226, v226
    v_exp_f32 v211, v211
    v_exp_f32 v227, v227
    v_exp_f32 v212, v212
    v_exp_f32 v228, v228
    v_exp_f32 v213, v213
    v_exp_f32 v229, v229
    v_exp_f32 v214, v214
    v_exp_f32 v230, v230
    v_exp_f32 v215, v215
    v_exp_f32 v231, v231
    v_exp_f32 v216, v216
    v_exp_f32 v232, v232
    v_exp_f32 v217, v217
    v_exp_f32 v233, v233
    v_exp_f32 v218, v218
    v_exp_f32 v234, v234
    v_exp_f32 v219, v219
    v_exp_f32 v235, v235
    v_exp_f32 v220, v220
    v_exp_f32 v236, v236
    v_exp_f32 v221, v221
    v_exp_f32 v237, v237
    v_add_f32 v243, v206, v207
    v_add_f32 v244, v222, v223
    v_add_f32 v245, v208, v209
    v_add_f32 v246, v224, v225
    v_add_f32 v243, v243, v210
    v_add_f32 v244, v244, v226
    v_add_f32 v245, v245, v211
    v_add_f32 v246, v246, v227
    v_add_f32 v243, v243, v212
    v_add_f32 v244, v244, v228
    v_add_f32 v245, v245, v213
    v_add_f32 v246, v246, v229
    v_add_f32 v243, v243, v214
    v_add_f32 v244, v244, v230
    v_add_f32 v245, v245, v215
    v_add_f32 v246, v246, v231
    v_add_f32 v243, v243, v216
    v_add_f32 v244, v244, v232
    v_add_f32 v245, v245, v217
    v_add_f32 v246, v246, v233
    v_add_f32 v243, v243, v218
    v_add_f32 v244, v244, v234
    v_add_f32 v245, v245, v219
    v_add_f32 v246, v246, v235
    v_add_f32 v243, v243, v220
    v_add_f32 v244, v244, v236
    v_add_f32 v245, v245, v221
    v_add_f32 v246, v246, v237
    v_add_f32 v243, v243, v245
    v_add_f32 v244, v244, v246
    v_mov_b32 v245, v243
    v_mov_b32 v246, v244
    s_nop 1
    v_permlane32_swap_b32 v243, v245
    v_permlane32_swap_b32 v244, v246
    s_nop 1
    v_add_f32 v243, v243, v245
    v_add_f32 v244, v244, v246
    v_rcp_f32 v243, v243
    v_rcp_f32 v244, v244
    s_nop 0
    v_mul_f32 v206, v206, v243
    v_mul_f32 v222, v222, v244
    v_mul_f32 v207, v207, v243
    v_mul_f32 v223, v223, v244
    v_mul_f32 v208, v208, v243
    v_mul_f32 v224, v224, v244
    v_mul_f32 v209, v209, v243
    v_mul_f32 v225, v225, v244
    v_mul_f32 v210, v210, v243
    v_mul_f32 v226, v226, v244
    v_mul_f32 v211, v211, v243
    v_mul_f32 v227, v227, v244
    v_mul_f32 v212, v212, v243
    v_mul_f32 v228, v228, v244
    v_mul_f32 v213, v213, v243
    v_mul_f32 v229, v229, v244
    v_mul_f32 v214, v214, v243
    v_mul_f32 v230, v230, v244
    v_mul_f32 v215, v215, v243
    v_mul_f32 v231, v231, v244
    v_mul_f32 v216, v216, v243
    v_mul_f32 v232, v232, v244
    v_mul_f32 v217, v217, v243
    v_mul_f32 v233, v233, v244
    v_mul_f32 v218, v218, v243
    v_mul_f32 v234, v234, v244
    v_mul_f32 v219, v219, v243
    v_mul_f32 v235, v235, v244
    v_mul_f32 v220, v220, v243
    v_mul_f32 v236, v236, v244
    v_mul_f32 v221, v221, v243
    v_mul_f32 v237, v237, v244
    v_cvt_pk_bf16_f32 v0, v206, v207
    v_cvt_pk_bf16_f32 v1, v208, v209
    v_cvt_pk_bf16_f32 v2, v210, v211
    v_cvt_pk_bf16_f32 v3, v212, v213
    v_cvt_pk_bf16_f32 v4, v214, v215
    v_cvt_pk_bf16_f32 v5, v216, v217
    v_cvt_pk_bf16_f32 v6, v218, v219
    v_cvt_pk_bf16_f32 v7, v220, v221
    v_cvt_pk_bf16_f32 v8, v222, v223
    v_cvt_pk_bf16_f32 v9, v224, v225
    v_cvt_pk_bf16_f32 v10, v226, v227
    v_cvt_pk_bf16_f32 v11, v228, v229
    v_cvt_pk_bf16_f32 v12, v230, v231
    v_cvt_pk_bf16_f32 v13, v232, v233
    v_cvt_pk_bf16_f32 v14, v234, v235
    v_cvt_pk_bf16_f32 v15, v236, v237
    s_waitcnt vmcnt(0) lgkmcnt(0)
    s_barrier
    s_lshl_b32 s39, s21, 7
    s_add_u32 s39, s39, 0x03008800
    s_cmp_lg_u32 s3, 0
    s_cbranch_scc1 .Lk2_nosig
    v_mov_b32 v245, 1
    v_mov_b32 v246, 0
    s_mov_b64 exec, 1
    buffer_atomic_add v245, v246, s[12:15], s39 offen sc1
    s_mov_b64 exec, -1
.Lk2_nosig:
    s_lshl_b32 s84, s20, 7
    s_add_u32 s84, s84, 0x03008400
    s_cmp_lt_u32 s3, 4
    s_cbranch_scc1 .Lk4e_a
    s_load_dwordx2 s[76:77], s[0:1], 56
    s_mov_b32 s78, 0x00700000
    s_mov_b32 s79, 0x00020000
    s_and_b32 s80, s2, 4
    s_lshr_b32 s81, s2, 6
    s_add_u32 s80, s80, s81
    s_and_b32 s82, s2, 1
    s_mul_i32 s82, s82, 3407872
    s_and_b32 s81, s3, 3
    s_lshl_b32 s83, s81, 12
    s_add_u32 s83, s83, 16384
    v_lshrrev_b32 v180, 4, v240
    v_and_b32 v181, 15, v240
    v_lshlrev_b32 v182, 1, v180
    v_xor_b32 v181, v181, v182
    s_lshl_b32 s81, s81, 4
    v_add_u32 v180, s81, v180
    v_lshlrev_b32 v180, 11, v180
    v_lshl_add_u32 v180, v181, 4, v180
    s_lshl_b32 s80, s80, 8
    v_add_u32 v176, s80, v180
    v_xor_b32 v177, 128, v176
    v_add_u32 v178, 14336, v176
    v_add_u32 v179, 21504, v177
    v_add_u32 v177, 7168, v177
    s_waitcnt lgkmcnt(0)
    s_add_u32 m0, s83, 0
    s_nop 0
    buffer_load_dwordx4 v176, s[76:79], s82 offen offset:0 lds
    buffer_load_dwordx4 v177, s[76:79], s82 offen offset:1024 lds
    buffer_load_dwordx4 v178, s[76:79], s82 offen offset:2048 lds
    buffer_load_dwordx4 v179, s[76:79], s82 offen offset:3072 lds
    s_add_u32 s82, s82, 131072
    s_add_u32 m0, s83, 32768
    s_nop 0
    buffer_load_dwordx4 v176, s[76:79], s82 offen offset:0 lds
    buffer_load_dwordx4 v177, s[76:79], s82 offen offset:1024 lds
    buffer_load_dwordx4 v178, s[76:79], s82 offen offset:2048 lds
    buffer_load_dwordx4 v179, s[76:79], s82 offen offset:3072 lds
    s_add_u32 s82, s82, 131072
    s_add_u32 m0, s83, 65536
    s_nop 0
    buffer_load_dwordx4 v176, s[76:79], s82 offen offset:0 lds
    buffer_load_dwordx4 v177, s[76:79], s82 offen offset:1024 lds
    buffer_load_dwordx4 v178, s[76:79], s82 offen offset:2048 lds
    buffer_load_dwordx4 v179, s[76:79], s82 offen offset:3072 lds
    s_add_u32 s82, s82, 131072
    s_add_u32 m0, s83, 98304
    s_nop 0
    buffer_load_dwordx4 v176, s[76:79], s82 offen offset:0 lds
    buffer_load_dwordx4 v177, s[76:79], s82 offen offset:1024 lds
    buffer_load_dwordx4 v178, s[76:79], s82 offen offset:2048 lds
    buffer_load_dwordx4 v179, s[76:79], s82 offen offset:3072 lds
    s_add_u32 s82, s82, 131072
    s_add_u32 m0, s83, 131072
    s_nop 0
    buffer_load_dwordx4 v176, s[76:79], s82 offen offset:0 lds
    buffer_load_dwordx4 v177, s[76:79], s82 offen offset:1024 lds
    buffer_load_dwordx4 v178, s[76:79], s82 offen offset:2048 lds
    buffer_load_dwordx4 v179, s[76:79], s82 offen offset:3072 lds
    s_add_u32 s82, s82, 131072
.Lk4e_a:
    v_cvt_pk_bf16_f32 v16, v16, v17
    v_cvt_pk_bf16_f32 v17, v18, v19
    v_cvt_pk_bf16_f32 v18, v20, v21
    v_cvt_pk_bf16_f32 v19, v22, v23
    v_cvt_pk_bf16_f32 v20, v24, v25
    v_cvt_pk_bf16_f32 v21, v26, v27
    v_cvt_pk_bf16_f32 v22, v28, v29
    v_cvt_pk_bf16_f32 v23, v30, v31
    s_nop 1
    v_mfma_f32_32x32x16_bf16 v[160:175], v[186:189], v[16:19], 0
    v_mfma_f32_32x32x16_bf16 v[160:175], v[190:193], v[20:23], v[160:175]
    s_nop 15
    s_nop 3
    v_max3_f32 v241, v160, v161, v162
    v_min3_f32 v242, v160, v161, v162
    v_max3_f32 v241, v241, v163, v164
    v_min3_f32 v242, v242, v163, v164
    v_max3_f32 v241, v241, v165, v166
    v_min3_f32 v242, v242, v165, v166
    v_max3_f32 v241, v241, v167, v168
    v_min3_f32 v242, v242, v167, v168
    v_max3_f32 v241, v241, v169, v170
    v_min3_f32 v242, v242, v169, v170
    v_max3_f32 v241, v241, v171, v172
    v_min3_f32 v242, v242, v171, v172
    v_max3_f32 v241, v241, v173, v174
    v_min3_f32 v242, v242, v173, v174
    v_max_f32 v241, v241, v175
    v_min_f32 v242, v242, v175
    v_mov_b32 v245, v241
    v_mov_b32 v246, v242
    s_nop 1
    v_permlane32_swap_b32 v241, v245
    v_permlane32_swap_b32 v242, v246
    s_nop 1
    v_max_f32 v241, v241, v245
    v_min_f32 v242, v242, v246
    v_mul_f32 v241, s48, v241
    v_mul_f32 v242, s48, v242
    v_fma_f32 v206, v160, s48, -v241
    v_fma_f32 v222, -v160, s48, v242
    v_fma_f32 v207, v161, s48, -v241
    v_fma_f32 v223, -v161, s48, v242
    v_fma_f32 v208, v162, s48, -v241
    v_fma_f32 v224, -v162, s48, v242
    v_fma_f32 v209, v163, s48, -v241
    v_fma_f32 v225, -v163, s48, v242
    v_fma_f32 v210, v164, s48, -v241
    v_fma_f32 v226, -v164, s48, v242
    v_fma_f32 v211, v165, s48, -v241
    v_fma_f32 v227, -v165, s48, v242
    v_fma_f32 v212, v166, s48, -v241
    v_fma_f32 v228, -v166, s48, v242
    v_fma_f32 v213, v167, s48, -v241
    v_fma_f32 v229, -v167, s48, v242
    v_fma_f32 v214, v168, s48, -v241
    v_fma_f32 v230, -v168, s48, v242
    v_fma_f32 v215, v169, s48, -v241
    v_fma_f32 v231, -v169, s48, v242
    v_fma_f32 v216, v170, s48, -v241
    v_fma_f32 v232, -v170, s48, v242
    v_fma_f32 v217, v171, s48, -v241
    v_fma_f32 v233, -v171, s48, v242
    v_fma_f32 v218, v172, s48, -v241
    v_fma_f32 v234, -v172, s48, v242
    v_fma_f32 v219, v173, s48, -v241
    v_fma_f32 v235, -v173, s48, v242
    v_fma_f32 v220, v174, s48, -v241
    v_fma_f32 v236, -v174, s48, v242
    v_fma_f32 v221, v175, s48, -v241
    v_fma_f32 v237, -v175, s48, v242
    v_exp_f32 v206, v206
    v_exp_f32 v222, v222
    v_exp_f32 v207, v207
    v_exp_f32 v223, v223
    v_exp_f32 v208, v208
    v_exp_f32 v224, v224
    v_exp_f32 v209, v209
    v_exp_f32 v225, v225
    v_exp_f32 v210, v210
    v_exp_f32 v226, v226
    v_exp_f32 v211, v211
    v_exp_f32 v227, v227
    v_exp_f32 v212, v212
    v_exp_f32 v228, v228
    v_exp_f32 v213, v213
    v_exp_f32 v229, v229
    v_exp_f32 v214, v214
    v_exp_f32 v230, v230
    v_exp_f32 v215, v215
    v_exp_f32 v231, v231
    v_exp_f32 v216, v216
    v_exp_f32 v232, v232
    v_exp_f32 v217, v217
    v_exp_f32 v233, v233
    v_exp_f32 v218, v218
    v_exp_f32 v234, v234
    v_exp_f32 v219, v219
    v_exp_f32 v235, v235
    v_exp_f32 v220, v220
    v_exp_f32 v236, v236
    v_exp_f32 v221, v221
    v_exp_f32 v237, v237
    v_add_f32 v243, v206, v207
    v_add_f32 v244, v222, v223
    v_add_f32 v245, v208, v209
    v_add_f32 v246, v224, v225
    v_add_f32 v243, v243, v210
    v_add_f32 v244, v244, v226
    v_add_f32 v245, v245, v211
    v_add_f32 v246, v246, v227
    v_add_f32 v243, v243, v212
    v_add_f32 v244, v244, v228
    v_add_f32 v245, v245, v213
    v_add_f32 v246, v246, v229
    v_add_f32 v243, v243, v214
    v_add_f32 v244, v244, v230
    v_add_f32 v245, v245, v215
    v_add_f32 v246, v246, v231
    v_add_f32 v243, v243, v216
    v_add_f32 v244, v244, v232
    v_add_f32 v245, v245, v217
    v_add_f32 v246, v246, v233
    v_add_f32 v243, v243, v218
    v_add_f32 v244, v244, v234
    v_add_f32 v245, v245, v219
    v_add_f32 v246, v246, v235
    v_add_f32 v243, v243, v220
    v_add_f32 v244, v244, v236
    v_add_f32 v245, v245, v221
    v_add_f32 v246, v246, v237
    v_add_f32 v243, v243, v245
    v_add_f32 v244, v244, v246
    v_mov_b32 v245, v243
    v_mov_b32 v246, v244
    s_nop 1
    v_permlane32_swap_b32 v243, v245
    v_permlane32_swap_b32 v244, v246
    s_nop 1
    v_add_f32 v243, v243, v245
    v_add_f32 v244, v244, v246
    v_rcp_f32 v243, v243
    v_rcp_f32 v244, v244
    s_nop 0
    v_mul_f32 v206, v206, v243
    v_mul_f32 v222, v222, v244
    v_mul_f32 v207, v207, v243
    v_mul_f32 v223, v223, v244
    v_mul_f32 v208, v208, v243
    v_mul_f32 v224, v224, v244
    v_mul_f32 v209, v209, v243
    v_mul_f32 v225, v225, v244
    v_mul_f32 v210, v210, v243
    v_mul_f32 v226, v226, v244
    v_mul_f32 v211, v211, v243
    v_mul_f32 v227, v227, v244
    v_mul_f32 v212, v212, v243
    v_mul_f32 v228, v228, v244
    v_mul_f32 v213, v213, v243
    v_mul_f32 v229, v229, v244
    v_mul_f32 v214, v214, v243
    v_mul_f32 v230, v230, v244
    v_mul_f32 v215, v215, v243
    v_mul_f32 v231, v231, v244
    v_mul_f32 v216, v216, v243
    v_mul_f32 v232, v232, v244
    v_mul_f32 v217, v217, v243
    v_mul_f32 v233, v233, v244
    v_mul_f32 v218, v218, v243
    v_mul_f32 v234, v234, v244
    v_mul_f32 v219, v219, v243
    v_mul_f32 v235, v235, v244
    v_mul_f32 v220, v220, v243
    v_mul_f32 v236, v236, v244
    v_mul_f32 v221, v221, v243
    v_mul_f32 v237, v237, v244
    v_cvt_pk_bf16_f32 v16, v206, v207
    v_cvt_pk_bf16_f32 v17, v208, v209
    v_cvt_pk_bf16_f32 v18, v210, v211
    v_cvt_pk_bf16_f32 v19, v212, v213
    v_cvt_pk_bf16_f32 v20, v214, v215
    v_cvt_pk_bf16_f32 v21, v216, v217
    v_cvt_pk_bf16_f32 v22, v218, v219
    v_cvt_pk_bf16_f32 v23, v220, v221
    v_cvt_pk_bf16_f32 v24, v222, v223
    v_cvt_pk_bf16_f32 v25, v224, v225
    v_cvt_pk_bf16_f32 v26, v226, v227
    v_cvt_pk_bf16_f32 v27, v228, v229
    v_cvt_pk_bf16_f32 v28, v230, v231
    v_cvt_pk_bf16_f32 v29, v232, v233
    v_cvt_pk_bf16_f32 v30, v234, v235
    v_cvt_pk_bf16_f32 v31, v236, v237
    s_cmp_lg_u32 s3, 0
    s_cbranch_scc1 .Lk2_polled
    s_mov_b32 s33, 200000
    v_mov_b32 v246, 0
.Lk2_poll:
    buffer_load_dword v245, v246, s[12:15], s39 offen sc1
    s_waitcnt vmcnt(0)
    v_readfirstlane_b32 s36, v245
    s_sub_u32 s33, s33, 1
    s_cmp_eq_u32 s33, 0
    s_cbranch_scc1 .Lk2_polled
    s_cmp_lt_u32 s36, 8
    s_cbranch_scc1 .Lk2_poll
.Lk2_polled:
    s_barrier
    s_lshl_b32 s36, s52, 16
    s_lshl_b32 s37, s22, 11
    s_add_u32 s36, s36, s37
    s_add_u32 s36, s36, 0x02000000
    s_lshl_b32 s37, s52, 11
    s_add_u32 s37, s37, 0x02400000
    buffer_load_dwordx4 v[96:99], v238, s[12:15], s36 offen offset:0 sc1
    buffer_load_dwordx4 v[100:103], v238, s[12:15], s36 offen offset:1024 sc1
    s_add_u32 s36, s36, 8192
    buffer_load_dwordx4 v[104:107], v238, s[12:15], s36 offen offset:0 sc1
    buffer_load_dwordx4 v[108:111], v238, s[12:15], s36 offen offset:1024 sc1
    s_add_u32 s36, s36, 8192
    buffer_load_dwordx4 v[112:115], v238, s[12:15], s36 offen offset:0 sc1
    buffer_load_dwordx4 v[116:119], v238, s[12:15], s36 offen offset:1024 sc1
    s_add_u32 s36, s36, 8192
    buffer_load_dwordx4 v[120:123], v238, s[12:15], s36 offen offset:0 sc1
    buffer_load_dwordx4 v[124:127], v238, s[12:15], s36 offen offset:1024 sc1
    s_add_u32 s36, s36, 8192
    buffer_load_dwordx4 v[128:131], v238, s[12:15], s36 offen offset:0 sc1
    buffer_load_dwordx4 v[132:135], v238, s[12:15], s36 offen offset:1024 sc1
    s_add_u32 s36, s36, 8192
    buffer_load_dwordx4 v[136:139], v238, s[12:15], s36 offen offset:0 sc1
    buffer_load_dwordx4 v[140:143], v238, s[12:15], s36 offen offset:1024 sc1
    s_add_u32 s36, s36, 8192
    buffer_load_dwordx4 v[144:147], v238, s[12:15], s36 offen offset:0 sc1
    buffer_load_dwordx4 v[148:151], v238, s[12:15], s36 offen offset:1024 sc1
    s_add_u32 s36, s36, 8192
    buffer_load_dwordx4 v[152:155], v238, s[12:15], s36 offen offset:0 sc1
    buffer_load_dwordx4 v[156:159], v238, s[12:15], s36 offen offset:1024 sc1
    buffer_load_dword v160, v239, s[12:15], s37 offen offset:0 sc1
    buffer_load_dword v161, v239, s[12:15], s37 offen offset:256 sc1
    buffer_load_dword v162, v239, s[12:15], s37 offen offset:512 sc1
    buffer_load_dword v163, v239, s[12:15], s37 offen offset:768 sc1
    buffer_load_dword v164, v239, s[12:15], s37 offen offset:1024 sc1
    buffer_load_dword v165, v239, s[12:15], s37 offen offset:1280 sc1
    buffer_load_dword v166, v239, s[12:15], s37 offen offset:1536 sc1
    buffer_load_dword v167, v239, s[12:15], s37 offen offset:1792 sc1
    s_lshl_b32 s36, s3, 10
    s_add_u32 s36, s36, 67584
    v_add_u32 v245, s36, v238
    s_lshl_b32 s36, s3, 7
    s_add_u32 s36, s36, 75776
    v_lshlrev_b32 v246, 1, v240
    v_add_u32 v246, s36, v246
    v_lshrrev_b32 v247, 5, v240
    v_lshlrev_b32 v247, 3, v247
    v_add_u32 v247, s36, v247
    s_lshl_b32 s36, s23, 12
    s_add_u32 s36, s36, 67584
    v_add_u32 v241, s36, v238
    s_waitcnt vmcnt(20)
    v_add_f32 v96, v96, v104
    v_add_f32 v97, v97, v105
    v_add_f32 v98, v98, v106
    v_add_f32 v99, v99, v107
    v_add_f32 v100, v100, v108
    v_add_f32 v101, v101, v109
    v_add_f32 v102, v102, v110
    v_add_f32 v103, v103, v111
    s_waitcnt vmcnt(18)
    v_add_f32 v96, v96, v112
    v_add_f32 v97, v97, v113
    v_add_f32 v98, v98, v114
    v_add_f32 v99, v99, v115
    v_add_f32 v100, v100, v116
    v_add_f32 v101, v101, v117
    v_add_f32 v102, v102, v118
    v_add_f32 v103, v103, v119
    s_waitcnt vmcnt(16)
    v_add_f32 v96, v96, v120
    v_add_f32 v97, v97, v121
    v_add_f32 v98, v98, v122
    v_add_f32 v99, v99, v123
    v_add_f32 v100, v100, v124
    v_add_f32 v101, v101, v125
    v_add_f32 v102, v102, v126
    v_add_f32 v103, v103, v127
    s_waitcnt vmcnt(14)
    v_add_f32 v96, v96, v128
    v_add_f32 v97, v97, v129
    v_add_f32 v98, v98, v130
    v_add_f32 v99, v99, v131
    v_add_f32 v100, v100, v132
    v_add_f32 v101, v101, v133
    v_add_f32 v102, v102, v134
    v_add_f32 v103, v103, v135
    s_waitcnt vmcnt(12)
    v_add_f32 v96, v96, v136
    v_add_f32 v97, v97, v137
    v_add_f32 v98, v98, v138
    v_add_f32 v99, v99, v139
    v_add_f32 v100, v100, v140
    v_add_f32 v101, v101, v141
    v_add_f32 v102, v102, v142
    v_add_f32 v103, v103, v143
    s_waitcnt vmcnt(10)
    v_add_f32 v96, v96, v144
    v_add_f32 v97, v97, v145
    v_add_f32 v98, v98, v146
    v_add_f32 v99, v99, v147
    v_add_f32 v100, v100, v148
    v_add_f32 v101, v101, v149
    v_add_f32 v102, v102, v150
    v_add_f32 v103, v103, v151
    s_waitcnt vmcnt(8)
    v_add_f32 v96, v96, v152
    v_add_f32 v97, v97, v153
    v_add_f32 v98, v98, v154
    v_add_f32 v99, v99, v155
    v_add_f32 v100, v100, v156
    v_add_f32 v101, v101, v157
    v_add_f32 v102, v102, v158
    v_add_f32 v103, v103, v159
    v_cvt_pk_bf16_f32 v96, v96, v97
    v_cvt_pk_bf16_f32 v97, v98, v99
    v_cvt_pk_bf16_f32 v98, v100, v101
    v_cvt_pk_bf16_f32 v99, v102, v103
    ds_write_b128 v245, v[96:99]
    s_waitcnt vmcnt(0)
    v_add_f32 v160, v160, v164
    v_add_f32 v161, v161, v165
    v_add_f32 v162, v162, v166
    v_add_f32 v163, v163, v167
    v_add_f32 v160, v160, v162
    v_add_f32 v161, v161, v163
    v_add_f32 v160, v160, v161
    v_cvt_pk_bf16_f32 v160, v160, v160
    ds_write_b16 v246, v160
    s_waitcnt lgkmcnt(0)
    s_barrier
    ds_read_b128 v[96:99], v241 offset:0
    ds_read_b128 v[100:103], v241 offset:1024
    ds_read_b128 v[104:107], v241 offset:2048
    ds_read_b128 v[108:111], v241 offset:3072
    ds_read2_b64 v[112:115], v247 offset0:0 offset1:2
    ds_read2_b64 v[116:119], v247 offset0:4 offset1:6
    ds_read2_b64 v[120:123], v247 offset0:8 offset1:10
    ds_read2_b64 v[124:127], v247 offset0:12 offset1:14
    s_lshl_b32 s36, s20, 1
    s_lshr_b32 s37, s22, 1
    s_add_u32 s36, s36, s37
    s_mul_i32 s36, s36, 144
    s_add_u32 s36, s36, s52
    s_add_u32 s36, s36, 112
    s_lshl_b32 s36, s36, 13
    s_add_u32 s36, s36, 0x00800000
    s_and_b32 s37, s22, 1
    s_lshl_b32 s37, s37, 10
    s_add_u32 s36, s36, s37
    s_add_u32 s37, s36, 4096
    v_lshrrev_b32 v245, 5, v240
    v_lshlrev_b32 v245, 11, v245
    v_and_b32 v246, 31, v240
    v_lshl_add_u32 v245, v246, 4, v245
    s_waitcnt lgkmcnt(0)
    v_mfma_f32_32x32x16_bf16 v[160:175], v[112:115], v[0:3], 0
    v_mfma_f32_32x32x16_bf16 v[128:143], v[96:99], v[0:3], 0
    v_mfma_f32_32x32x16_bf16 v[160:175], v[116:119], v[4:7], v[160:175]
    v_mfma_f32_32x32x16_bf16 v[128:143], v[100:103], v[4:7], v[128:143]
    v_mfma_f32_32x32x16_bf16 v[160:175], v[120:123], v[8:11], v[160:175]
    v_mfma_f32_32x32x16_bf16 v[128:143], v[104:107], v[8:11], v[128:143]
    v_mfma_f32_32x32x16_bf16 v[160:175], v[124:127], v[12:15], v[160:175]
    v_mfma_f32_32x32x16_bf16 v[128:143], v[108:111], v[12:15], v[128:143]
    v_mfma_f32_32x32x16_bf16 v[206:221], v[112:115], v[16:19], 0
    v_mfma_f32_32x32x16_bf16 v[144:159], v[96:99], v[16:19], 0
    v_mfma_f32_32x32x16_bf16 v[206:221], v[116:119], v[20:23], v[206:221]
    v_mfma_f32_32x32x16_bf16 v[144:159], v[100:103], v[20:23], v[144:159]
    v_mfma_f32_32x32x16_bf16 v[206:221], v[120:123], v[24:27], v[206:221]
    v_mfma_f32_32x32x16_bf16 v[144:159], v[104:107], v[24:27], v[144:159]
    v_mfma_f32_32x32x16_bf16 v[206:221], v[124:127], v[28:31], v[206:221]
    v_mfma_f32_32x32x16_bf16 v[144:159], v[108:111], v[28:31], v[144:159]
    s_nop 15
    s_nop 3
    v_add_f32 v160, 0x358637bd, v160
    v_rcp_f32 v160, v160
    s_nop 0
    v_mul_f32 v128, v128, v160
    v_mul_f32 v129, v129, v160
    v_mul_f32 v130, v130, v160
    v_mul_f32 v131, v131, v160
    v_mul_f32 v132, v132, v160
    v_mul_f32 v133, v133, v160
    v_mul_f32 v134, v134, v160
    v_mul_f32 v135, v135, v160
    v_mul_f32 v136, v136, v160
    v_mul_f32 v137, v137, v160
    v_mul_f32 v138, v138, v160
    v_mul_f32 v139, v139, v160
    v_mul_f32 v140, v140, v160
    v_mul_f32 v141, v141, v160
    v_mul_f32 v142, v142, v160
    v_mul_f32 v143, v143, v160
    v_cvt_pk_bf16_f32 v32, v128, v129
    v_cvt_pk_bf16_f32 v33, v130, v131
    v_cvt_pk_bf16_f32 v36, v132, v133
    v_cvt_pk_bf16_f32 v37, v134, v135
    v_cvt_pk_bf16_f32 v34, v136, v137
    v_cvt_pk_bf16_f32 v35, v138, v139
    v_cvt_pk_bf16_f32 v38, v140, v141
    v_cvt_pk_bf16_f32 v39, v142, v143
    buffer_store_dwordx4 v[32:35], v245, s[12:15], s36 offen offset:0 sc1
    buffer_store_dwordx4 v[36:39], v245, s[12:15], s37 offen offset:0 sc1
    v_add_f32 v206, 0x358637bd, v206
    v_rcp_f32 v206, v206
    s_nop 0
    v_mul_f32 v144, v144, v206
    v_mul_f32 v145, v145, v206
    v_mul_f32 v146, v146, v206
    v_mul_f32 v147, v147, v206
    v_mul_f32 v148, v148, v206
    v_mul_f32 v149, v149, v206
    v_mul_f32 v150, v150, v206
    v_mul_f32 v151, v151, v206
    v_mul_f32 v152, v152, v206
    v_mul_f32 v153, v153, v206
    v_mul_f32 v154, v154, v206
    v_mul_f32 v155, v155, v206
    v_mul_f32 v156, v156, v206
    v_mul_f32 v157, v157, v206
    v_mul_f32 v158, v158, v206
    v_mul_f32 v159, v159, v206
    v_cvt_pk_bf16_f32 v40, v144, v145
    v_cvt_pk_bf16_f32 v41, v146, v147
    v_cvt_pk_bf16_f32 v44, v148, v149
    v_cvt_pk_bf16_f32 v45, v150, v151
    v_cvt_pk_bf16_f32 v42, v152, v153
    v_cvt_pk_bf16_f32 v43, v154, v155
    v_cvt_pk_bf16_f32 v46, v156, v157
    v_cvt_pk_bf16_f32 v47, v158, v159
    buffer_store_dwordx4 v[40:43], v245, s[12:15], s36 offen offset:512 sc1
    buffer_store_dwordx4 v[44:47], v245, s[12:15], s37 offen offset:512 sc1
.Lk2_end:
    s_waitcnt vmcnt(0) lgkmcnt(0)
    s_barrier
    s_cmp_lg_u32 s3, 5
    s_cbranch_scc1 .Lk2_nosig2
    v_mov_b32 v1, 1
    v_mov_b32 v2, 0
    s_mov_b64 exec, 1
    buffer_atomic_add v1, v2, s[12:15], s84 offen sc1
    s_mov_b64 exec, -1
.Lk2_nosig2:
    s_load_dwordx2 s[4:5], s[0:1], 88
    s_load_dwordx2 s[8:9], s[0:1], 56
    s_load_dwordx2 s[12:13], s[0:1], 24
    s_load_dwordx2 s[16:17], s[0:1], 0
    s_load_dwordx2 s[20:21], s[0:1], 64
    v_mov_b32 v184, v240
    s_and_b32 s40, s2, 7
    s_lshr_b32 s41, s2, 3
    s_and_b32 s26, s40, 1
    s_bfe_u32 s42, s40, 0x10001
    s_lshl_b32 s42, s42, 3
    s_and_b32 s24, s41, 7
    s_add_u32 s24, s24, s42
    s_lshr_b32 s42, s40, 2
    s_lshl_b32 s42, s42, 2
    s_lshr_b32 s25, s41, 3
    s_add_u32 s25, s25, s42
    s_mov_b32 s6, 0x10000000
    s_mov_b32 s7, 0x00020000
    s_mov_b32 s10, 0x00700000
    s_mov_b32 s11, 0x00020000
    s_mov_b32 s14, 0x00200000
    s_mov_b32 s15, 0x00020000
    s_mov_b32 s18, 0x00400000
    s_mov_b32 s19, 0x00020000
    s_mov_b32 s22, 2048
    s_mov_b32 s23, 0x00020000
    s_mov_b32 s30, 0
    s_cmp_eq_u32 s26, 0
    s_cselect_b32 s37, 26, 30
    s_lshr_b32 s38, s24, 1
    s_lshl_b32 s38, s38, 7
    s_add_u32 s38, s38, 0x03008000
    s_cmp_lt_u32 s3, 4
    s_cbranch_scc1 .Lk4_cons
    s_and_b32 s27, s3, 3
    s_lshl_b32 s35, s27, 12
    s_add_u32 s36, s35, 16384
    v_lshlrev_b32 v2, 4, v184
    v_add_u32 v2, s35, v2
    s_mul_i32 s33, s24, 1179648
    s_add_u32 s33, s33, 0x00800000
    s_add_u32 s53, s33, 917504
    s_mul_i32 s40, s26, 425984
    s_add_u32 s33, s33, s40
    s_mul_i32 s34, s26, 3407872
    v_lshrrev_b32 v188, 5, v184
    v_and_b32 v189, 31, v184
    v_lshl_add_u32 v188, v188, 6, v189
    s_lshl_b32 s40, s26, 5
    v_add_u32 v188, s40, v188
    v_lshlrev_b32 v188, 4, v188
    v_add_u32 v3, s35, v188
    v_add_u32 v4, 1024, v3
    s_waitcnt lgkmcnt(0)
    s_cmp_lg_u32 s3, 4
    s_cbranch_scc1 .Lk4_hok
    s_mov_b32 s41, 200000
    v_mov_b32 v189, 0
.Lk4_hpoll:
    buffer_load_dword v188, v189, s[4:7], s38 offen sc1
    s_waitcnt vmcnt(0)
    v_readfirstlane_b32 s40, v188
    s_sub_u32 s41, s41, 1
    s_cmp_eq_u32 s41, 0
    s_cbranch_scc1 .Lk4_hok
    s_cmp_lt_u32 s40, 16
    s_cbranch_scc1 .Lk4_hpoll
.Lk4_hok:
    s_barrier
    s_add_u32 m0, s35, 0
    s_nop 0
    buffer_load_dwordx4 v2, s[4:7], s33 offen offset:0 sc1 lds
    buffer_load_dwordx4 v2, s[4:7], s33 offen offset:1024 sc1 lds
    buffer_load_dwordx4 v2, s[4:7], s33 offen offset:2048 sc1 lds
    buffer_load_dwordx4 v2, s[4:7], s33 offen offset:3072 sc1 lds
    s_add_u32 s33, s33, 16384
    s_add_u32 m0, s35, 32768
    s_nop 0
    buffer_load_dwordx4 v2, s[4:7], s33 offen offset:0 sc1 lds
    buffer_load_dwordx4 v2, s[4:7], s33 offen offset:1024 sc1 lds
    buffer_load_dwordx4 v2, s[4:7], s33 offen offset:2048 sc1 lds
    buffer_load_dwordx4 v2, s[4:7], s33 offen offset:3072 sc1 lds
    s_add_u32 s33, s33, 16384
    s_add_u32 m0, s35, 65536
    s_nop 0
    buffer_load_dwordx4 v2, s[4:7], s33 offen offset:0 sc1 lds
    buffer_load_dwordx4 v2, s[4:7], s33 offen offset:1024 sc1 lds
    buffer_load_dwordx4 v2, s[4:7], s33 offen offset:2048 sc1 lds
    buffer_load_dwordx4 v2, s[4:7], s33 offen offset:3072 sc1 lds
    s_add_u32 s33, s33, 16384
    s_add_u32 m0, s35, 98304
    s_nop 0
    buffer_load_dwordx4 v2, s[4:7], s33 offen offset:0 sc1 lds
    buffer_load_dwordx4 v2, s[4:7], s33 offen offset:1024 sc1 lds
    buffer_load_dwordx4 v2, s[4:7], s33 offen offset:2048 sc1 lds
    buffer_load_dwordx4 v2, s[4:7], s33 offen offset:3072 sc1 lds
    s_add_u32 s33, s33, 16384
    s_add_u32 m0, s35, 131072
    s_nop 0
    buffer_load_dwordx4 v2, s[4:7], s33 offen offset:0 sc1 lds
    buffer_load_dwordx4 v2, s[4:7], s33 offen offset:1024 sc1 lds
    buffer_load_dwordx4 v2, s[4:7], s33 offen offset:2048 sc1 lds
    buffer_load_dwordx4 v2, s[4:7], s33 offen offset:3072 sc1 lds
    s_add_u32 s33, s33, 16384
    s_add_u32 s34, s34, 655360
    s_waitcnt vmcnt(16)
    s_barrier
    s_waitcnt vmcnt(12)
    s_barrier
    s_add_u32 m0, s30, s36
    s_nop 0
    buffer_load_dwordx4 v176, s[8:11], s34 offen offset:0 lds
    buffer_load_dwordx4 v177, s[8:11], s34 offen offset:1024 lds
    buffer_load_dwordx4 v178, s[8:11], s34 offen offset:2048 lds
    buffer_load_dwordx4 v179, s[8:11], s34 offen offset:3072 lds
    s_add_u32 m0, s30, s35
    s_nop 0
    buffer_load_dwordx4 v2, s[4:7], s33 offen offset:0 sc1 lds
    buffer_load_dwordx4 v2, s[4:7], s33 offen offset:1024 sc1 lds
    buffer_load_dwordx4 v2, s[4:7], s33 offen offset:2048 sc1 lds
    buffer_load_dwordx4 v2, s[4:7], s33 offen offset:3072 sc1 lds
    s_add_u32 s33, s33, 16384
    s_add_u32 s34, s34, 131072
    s_add_u32 s30, s30, 32768
    s_cmp_ge_u32 s30, 163840
    s_cselect_b32 s30, 0, s30
    s_waitcnt vmcnt(16)
    s_barrier
    s_add_u32 m0, s30, s36
    s_nop 0
    buffer_load_dwordx4 v176, s[8:11], s34 offen offset:0 lds
    buffer_load_dwordx4 v177, s[8:11], s34 offen offset:1024 lds
    buffer_load_dwordx4 v178, s[8:11], s34 offen offset:2048 lds
    buffer_load_dwordx4 v179, s[8:11], s34 offen offset:3072 lds
    s_add_u32 m0, s30, s35
    s_nop 0
    buffer_load_dwordx4 v2, s[4:7], s33 offen offset:0 sc1 lds
    buffer_load_dwordx4 v2, s[4:7], s33 offen offset:1024 sc1 lds
    buffer_load_dwordx4 v2, s[4:7], s33 offen offset:2048 sc1 lds
    buffer_load_dwordx4 v2, s[4:7], s33 offen offset:3072 sc1 lds
    s_add_u32 s33, s33, 16384
    s_add_u32 s34, s34, 131072
    s_add_u32 s30, s30, 32768
    s_cmp_ge_u32 s30, 163840
    s_cselect_b32 s30, 0, s30
    s_waitcnt vmcnt(20)
    s_barrier
    s_add_u32 m0, s30, s36
    s_nop 0
    buffer_load_dwordx4 v176, s[8:11], s34 offen offset:0 lds
    buffer_load_dwordx4 v177, s[8:11], s34 offen offset:1024 lds
    buffer_load_dwordx4 v178, s[8:11], s34 offen offset:2048 lds
    buffer_load_dwordx4 v179, s[8:11], s34 offen offset:3072 lds
    s_add_u32 m0, s30, s35
    s_nop 0
    buffer_load_dwordx4 v2, s[4:7], s33 offen offset:0 sc1 lds
    buffer_load_dwordx4 v2, s[4:7], s33 offen offset:1024 sc1 lds
    buffer_load_dwordx4 v2, s[4:7], s33 offen offset:2048 sc1 lds
    buffer_load_dwordx4 v2, s[4:7], s33 offen offset:3072 sc1 lds
    s_add_u32 s33, s33, 16384
    s_add_u32 s34, s34, 131072
    s_add_u32 s30, s30, 32768
    s_cmp_ge_u32 s30, 163840
    s_cselect_b32 s30, 0, s30
    s_sub_u32 s32, s37, 8
.Lk4_pm:
    s_waitcnt vmcnt(24)
    s_barrier
    s_add_u32 m0, s30, s36
    s_nop 0
    buffer_load_dwordx4 v176, s[8:11], s34 offen offset:0 lds
    buffer_load_dwordx4 v177, s[8:11], s34 offen offset:1024 lds
    buffer_load_dwordx4 v178, s[8:11], s34 offen offset:2048 lds
    buffer_load_dwordx4 v179, s[8:11], s34 offen offset:3072 lds
    s_add_u32 m0, s30, s35
    s_nop 0
    buffer_load_dwordx4 v2, s[4:7], s33 offen offset:0 sc1 lds
    buffer_load_dwordx4 v2, s[4:7], s33 offen offset:1024 sc1 lds
    buffer_load_dwordx4 v2, s[4:7], s33 offen offset:2048 sc1 lds
    buffer_load_dwordx4 v2, s[4:7], s33 offen offset:3072 sc1 lds
    s_add_u32 s33, s33, 16384
    s_add_u32 s34, s34, 131072
    s_add_u32 s30, s30, 32768
    s_cmp_ge_u32 s30, 163840
    s_cselect_b32 s30, 0, s30
    s_sub_u32 s32, s32, 1
    s_cmp_lg_u32 s32, 0
    s_cbranch_scc1 .Lk4_pm
    s_mov_b32 s33, s53
    s_mov_b32 s34, 0
    s_lshr_b32 s35, s35, 1
    s_mov_b32 s32, 16
.Lk4_ps:
    s_waitcnt vmcnt(18)
    s_barrier
    s_add_u32 m0, s30, s36
    s_nop 0
    buffer_load_dwordx4 v176, s[12:15], s34 offen offset:0 lds
    buffer_load_dwordx4 v177, s[12:15], s34 offen offset:1024 lds
    buffer_load_dwordx4 v178, s[12:15], s34 offen offset:2048 lds
    buffer_load_dwordx4 v179, s[12:15], s34 offen offset:3072 lds
    s_add_u32 m0, s30, s35
    s_nop 0
    buffer_load_dwordx4 v3, s[4:7], s33 offen offset:0 sc1 lds
    buffer_load_dwordx4 v4, s[4:7], s33 offen offset:1024 sc1 lds
    s_add_u32 s33, s33, 16384
    s_add_u32 s34, s34, 131072
    s_add_u32 s30, s30, 32768
    s_cmp_ge_u32 s30, 163840
    s_cselect_b32 s30, 0, s30
    s_sub_u32 s32, s32, 1
    s_cmp_lg_u32 s32, 0
    s_cbranch_scc1 .Lk4_ps
    s_waitcnt vmcnt(18)
    s_barrier
    s_waitcnt vmcnt(12)
    s_barrier
    s_waitcnt vmcnt(6)
    s_barrier
    s_waitcnt vmcnt(0)
    s_barrier
    s_waitcnt vmcnt(0)
    s_branch .Lk4_end
.Lk4_cons:
    s_and_b32 s27, s3, 1
    s_lshr_b32 s28, s3, 1
    s_lshl_b32 s29, s24, 3
    s_add_u32 s29, s29, s25
    v_lshrrev_b32 v188, 4, v184
    v_and_b32 v189, 15, v184
    v_lshlrev_b32 v186, 4, v184
    v_mov_b32 v187, 0
    s_lshl_b32 s40, s25, 8
    s_lshl_b32 s41, s28, 7
    s_add_u32 s40, s40, s41
    v_lshlrev_b32 v190, 3, v188
    s_lshl_b32 s41, s24, 7
    s_lshl_b32 s42, s27, 6
    s_lshl_b32 s43, s26, 5
    s_add_u32 s42, s42, s43
    s_add_u32 s41, s41, s42
    v_add_u32 v185, s41, v189
    v_lshlrev_b32 v185, 11, v185
    v_and_b32 v191, 1, v188
    v_lshl_add_u32 v185, v191, 5, v185
    v_lshrrev_b32 v191, 1, v188
    v_lshl_add_u32 v185, v191, 4, v185
    v_add_u32 v185, s40, v185
    s_mov_b32 s53, 32768
    s_waitcnt lgkmcnt(0)
    buffer_load_dwordx2 v[128:129], v190, s[20:23], s40 offen offset:0
    buffer_load_dwordx2 v[130:131], v190, s[20:23], s40 offen offset:32
    buffer_load_dwordx2 v[132:133], v190, s[20:23], s40 offen offset:64
    buffer_load_dwordx2 v[134:135], v190, s[20:23], s40 offen offset:96
    buffer_load_dwordx4 v[160:163], v185, s[16:19], 0 offen offset:0
    buffer_load_dwordx4 v[164:167], v185, s[16:19], 0 offen offset:64
    buffer_load_dwordx4 v[168:171], v185, s[16:19], s53 offen offset:0
    buffer_load_dwordx4 v[172:175], v185, s[16:19], s53 offen offset:64
    s_barrier
    s_load_dwordx2 s[16:17], s[0:1], 72
    v_add_u32 v176, s42, v189
    v_lshlrev_b32 v176, 4, v176
    v_lshl_add_u32 v176, v188, 11, v176
    v_xor_b32 v177, 512, v176
    s_lshl_b32 s41, s27, 5
    v_add_u32 v178, s41, v189
    v_lshlrev_b32 v178, 4, v178
    v_lshl_add_u32 v178, v188, 10, v178
    s_cmp_eq_u32 s26, 0
    s_cselect_b32 s41, 2, 0
    s_lshl_b32 s41, s41, 14
    v_add_u32 v178, s41, v178
    v_lshrrev_b32 v189, 2, v184
    v_and_b32 v190, 7, v189
    v_lshlrev_b32 v190, 5, v190
    v_lshlrev_b32 v189, 8, v189
    v_and_b32 v191, 3, v184
    v_lshlrev_b32 v191, 3, v191
    s_lshl_b32 s41, s28, 7
    v_or_b32 v191, s41, v191
    v_xor_b32 v191, v191, v190
    v_add_u32 v189, 16384, v189
    v_add_u32 v180, v189, v191
    v_xor_b32 v181, 32, v180
    v_xor_b32 v182, 64, v180
    v_xor_b32 v183, 96, v180
    s_lshl_b32 s41, s29, 1
    s_add_u32 s41, s41, s26
    s_xor_b32 s42, s41, 1
    s_lshl_b32 s43, s3, 2
    s_add_u32 s43, s43, 0x03000000
    s_lshl_b32 s48, s41, 7
    s_add_u32 s48, s48, s43
    s_lshl_b32 s49, s42, 7
    s_add_u32 s49, s49, s43
    s_lshl_b32 s43, s3, 13
    s_add_u32 s43, s43, 0x02800000
    s_lshl_b32 s44, s41, 15
    s_add_u32 s44, s44, s43
    s_add_u32 s45, s44, 4096
    s_lshl_b32 s46, s42, 15
    s_add_u32 s46, s46, s43
    s_add_u32 s47, s46, 4096
    s_mov_b32 s50, 0x00000248
    s_mov_b32 s51, 0xbfb8aa3b
    s_mov_b32 s52, 0xffff0000
    v_mov_b32 v32, 0
    v_mov_b32 v33, 0
    v_mov_b32 v34, 0
    v_mov_b32 v35, 0
    v_mov_b32 v36, 0
    v_mov_b32 v37, 0
    v_mov_b32 v38, 0
    v_mov_b32 v39, 0
    v_mov_b32 v40, 0
    v_mov_b32 v41, 0
    v_mov_b32 v42, 0
    v_mov_b32 v43, 0
    v_mov_b32 v44, 0
    v_mov_b32 v45, 0
    v_mov_b32 v46, 0
    v_mov_b32 v47, 0
    v_mov_b32 v48, 0
    v_mov_b32 v49, 0
    v_mov_b32 v50, 0
    v_mov_b32 v51, 0
    v_mov_b32 v52, 0
    v_mov_b32 v53, 0
    v_mov_b32 v54, 0
    v_mov_b32 v55, 0
    v_mov_b32 v56, 0
    v_mov_b32 v57, 0
    v_mov_b32 v58, 0
    v_mov_b32 v59, 0
    v_mov_b32 v60, 0
    v_mov_b32 v61, 0
    v_mov_b32 v62, 0
    v_mov_b32 v63, 0
    v_mov_b32 v64, 0
    v_mov_b32 v65, 0
    v_mov_b32 v66, 0
    v_mov_b32 v67, 0
    v_mov_b32 v68, 0
    v_mov_b32 v69, 0
    v_mov_b32 v70, 0
    v_mov_b32 v71, 0
    v_mov_b32 v72, 0
    v_mov_b32 v73, 0
    v_mov_b32 v74, 0
    v_mov_b32 v75, 0
    v_mov_b32 v76, 0
    v_mov_b32 v77, 0
    v_mov_b32 v78, 0
    v_mov_b32 v79, 0
    v_mov_b32 v80, 0
    v_mov_b32 v81, 0
    v_mov_b32 v82, 0
    v_mov_b32 v83, 0
    v_mov_b32 v84, 0
    v_mov_b32 v85, 0
    v_mov_b32 v86, 0
    v_mov_b32 v87, 0
    v_mov_b32 v88, 0
    v_mov_b32 v89, 0
    v_mov_b32 v90, 0
    v_mov_b32 v91, 0
    v_mov_b32 v92, 0
    v_mov_b32 v93, 0
    v_mov_b32 v94, 0
    v_mov_b32 v95, 0
    s_waitcnt vmcnt(4)
    v_lshlrev_b32 v0, 16, v128
    v_and_b32 v1, s52, v128
    v_lshlrev_b32 v2, 16, v129
    v_and_b32 v3, s52, v129
    v_lshlrev_b32 v4, 16, v130
    v_and_b32 v5, s52, v130
    v_lshlrev_b32 v6, 16, v131
    v_and_b32 v7, s52, v131
    v_lshlrev_b32 v8, 16, v132
    v_and_b32 v9, s52, v132
    v_lshlrev_b32 v10, 16, v133
    v_and_b32 v11, s52, v133
    v_lshlrev_b32 v12, 16, v134
    v_and_b32 v13, s52, v134
    v_lshlrev_b32 v14, 16, v135
    v_and_b32 v15, s52, v135
    v_mov_b32 v16, v0
    v_mov_b32 v17, v1
    v_mov_b32 v18, v2
    v_mov_b32 v19, v3
    v_mov_b32 v20, v4
    v_mov_b32 v21, v5
    v_mov_b32 v22, v6
    v_mov_b32 v23, v7
    v_mov_b32 v24, v8
    v_mov_b32 v25, v9
    v_mov_b32 v26, v10
    v_mov_b32 v27, v11
    v_mov_b32 v28, v12
    v_mov_b32 v29, v13
    v_mov_b32 v30, v14
    v_mov_b32 v31, v15
    s_waitcnt lgkmcnt(0)
    s_barrier
    ds_read_b64_tr_b16 v[96:97], v180 offset:0
    ds_read_b64_tr_b16 v[98:99], v180 offset:4096
    ds_read_b128 v[112:115], v176 offset:0
    ds_read_b64_tr_b16 v[100:101], v181 offset:0
    ds_read_b64_tr_b16 v[102:103], v181 offset:4096
    ds_read_b128 v[116:119], v176 offset:256
    ds_read_b64_tr_b16 v[104:105], v182 offset:0
    ds_read_b64_tr_b16 v[106:107], v182 offset:4096
    ds_read_b128 v[120:123], v177 offset:0
    ds_read_b64_tr_b16 v[108:109], v183 offset:0
    ds_read_b64_tr_b16 v[110:111], v183 offset:4096
    ds_read_b128 v[124:127], v177 offset:256
    s_sub_u32 s32, s37, 1
.Lk4_cm:
    s_bitcmp1_b32 0x00000120, s32
    s_cbranch_scc1 .Lk4_mside
.Lk4_mback:
    s_waitcnt lgkmcnt(0)
    ds_read_b64_tr_b16 v[128:129], v180 offset:8192
    ds_read_b64_tr_b16 v[130:131], v180 offset:12288
    v_mfma_f32_16x16x32_bf16 v[0:3], v[96:99], v[112:115], v[0:3]
    ds_read_b128 v[144:147], v176 offset:8192
    v_mfma_f32_16x16x32_bf16 v[4:7], v[100:103], v[112:115], v[4:7]
    ds_read_b64_tr_b16 v[132:133], v181 offset:8192
    ds_read_b64_tr_b16 v[134:135], v181 offset:12288
    v_mfma_f32_16x16x32_bf16 v[8:11], v[104:107], v[112:115], v[8:11]
    ds_read_b128 v[148:151], v176 offset:8448
    v_mfma_f32_16x16x32_bf16 v[12:15], v[108:111], v[112:115], v[12:15]
    ds_read_b64_tr_b16 v[136:137], v182 offset:8192
    ds_read_b64_tr_b16 v[138:139], v182 offset:12288
    v_mfma_f32_16x16x32_bf16 v[16:19], v[96:99], v[116:119], v[16:19]
    ds_read_b128 v[152:155], v177 offset:8192
    v_mfma_f32_16x16x32_bf16 v[20:23], v[100:103], v[116:119], v[20:23]
    ds_read_b64_tr_b16 v[140:141], v183 offset:8192
    ds_read_b64_tr_b16 v[142:143], v183 offset:12288
    v_mfma_f32_16x16x32_bf16 v[24:27], v[104:107], v[116:119], v[24:27]
    ds_read_b128 v[156:159], v177 offset:8448
    v_mfma_f32_16x16x32_bf16 v[28:31], v[108:111], v[116:119], v[28:31]
    s_add_u32 s30, s30, 32768
    s_cmp_ge_u32 s30, 163840
    s_cselect_b32 s30, 0, s30
    s_cselect_b32 s31, -131072, s53
    v_mfma_f32_16x16x32_bf16 v[32:35], v[96:99], v[120:123], v[32:35]
    v_add_u32 v180, s31, v180
    v_add_u32 v181, s31, v181
    v_mfma_f32_16x16x32_bf16 v[36:39], v[100:103], v[120:123], v[36:39]
    v_add_u32 v182, s31, v182
    v_add_u32 v183, s31, v183
    v_mfma_f32_16x16x32_bf16 v[40:43], v[104:107], v[120:123], v[40:43]
    v_add_u32 v176, s31, v176
    v_add_u32 v177, s31, v177
    v_mfma_f32_16x16x32_bf16 v[44:47], v[108:111], v[120:123], v[44:47]
    v_mfma_f32_16x16x32_bf16 v[48:51], v[96:99], v[124:127], v[48:51]
    v_mfma_f32_16x16x32_bf16 v[52:55], v[100:103], v[124:127], v[52:55]
    s_waitcnt lgkmcnt(0)
    s_barrier
    v_mfma_f32_16x16x32_bf16 v[56:59], v[104:107], v[124:127], v[56:59]
    v_mfma_f32_16x16x32_bf16 v[60:63], v[108:111], v[124:127], v[60:63]
    v_mfma_f32_16x16x32_bf16 v[0:3], v[128:131], v[144:147], v[0:3]
    ds_read_b64_tr_b16 v[96:97], v180 offset:0
    ds_read_b64_tr_b16 v[98:99], v180 offset:4096
    v_mfma_f32_16x16x32_bf16 v[4:7], v[132:135], v[144:147], v[4:7]
    ds_read_b128 v[112:115], v176 offset:0
    v_mfma_f32_16x16x32_bf16 v[8:11], v[136:139], v[144:147], v[8:11]
    ds_read_b64_tr_b16 v[100:101], v181 offset:0
    ds_read_b64_tr_b16 v[102:103], v181 offset:4096
    v_mfma_f32_16x16x32_bf16 v[12:15], v[140:143], v[144:147], v[12:15]
    ds_read_b128 v[116:119], v176 offset:256
    v_mfma_f32_16x16x32_bf16 v[16:19], v[128:131], v[148:151], v[16:19]
    ds_read_b64_tr_b16 v[104:105], v182 offset:0
    ds_read_b64_tr_b16 v[106:107], v182 offset:4096
    v_mfma_f32_16x16x32_bf16 v[20:23], v[132:135], v[148:151], v[20:23]
    ds_read_b128 v[120:123], v177 offset:0
    v_mfma_f32_16x16x32_bf16 v[24:27], v[136:139], v[148:151], v[24:27]
    ds_read_b64_tr_b16 v[108:109], v183 offset:0
    ds_read_b64_tr_b16 v[110:111], v183 offset:4096
    v_mfma_f32_16x16x32_bf16 v[28:31], v[140:143], v[148:151], v[28:31]
    ds_read_b128 v[124:127], v177 offset:256
    v_mfma_f32_16x16x32_bf16 v[32:35], v[128:131], v[152:155], v[32:35]
    v_mfma_f32_16x16x32_bf16 v[36:39], v[132:135], v[152:155], v[36:39]
    v_mfma_f32_16x16x32_bf16 v[40:43], v[136:139], v[152:155], v[40:43]
    v_mfma_f32_16x16x32_bf16 v[44:47], v[140:143], v[152:155], v[44:47]
    v_mfma_f32_16x16x32_bf16 v[48:51], v[128:131], v[156:159], v[48:51]
    s_sub_u32 s32, s32, 1
    s_cmp_lg_u32 s32, 0
    v_mfma_f32_16x16x32_bf16 v[52:55], v[132:135], v[156:159], v[52:55]
    v_mfma_f32_16x16x32_bf16 v[56:59], v[136:139], v[156:159], v[56:59]
    v_mfma_f32_16x16x32_bf16 v[60:63], v[140:143], v[156:159], v[60:63]
    s_cbranch_scc1 .Lk4_cm
    s_waitcnt lgkmcnt(0)
    ds_read_b64_tr_b16 v[128:129], v180 offset:8192
    ds_read_b64_tr_b16 v[130:131], v180 offset:12288
    v_mfma_f32_16x16x32_bf16 v[0:3], v[96:99], v[112:115], v[0:3]
    ds_read_b128 v[144:147], v176 offset:8192
    v_mfma_f32_16x16x32_bf16 v[4:7], v[100:103], v[112:115], v[4:7]
    ds_read_b64_tr_b16 v[132:133], v181 offset:8192
    ds_read_b64_tr_b16 v[134:135], v181 offset:12288
    v_mfma_f32_16x16x32_bf16 v[8:11], v[104:107], v[112:115], v[8:11]
    ds_read_b128 v[148:151], v176 offset:8448
    v_mfma_f32_16x16x32_bf16 v[12:15], v[108:111], v[112:115], v[12:15]
    ds_read_b64_tr_b16 v[136:137], v182 offset:8192
    ds_read_b64_tr_b16 v[138:139], v182 offset:12288
    v_mfma_f32_16x16x32_bf16 v[16:19], v[96:99], v[116:119], v[16:19]
    ds_read_b128 v[152:155], v177 offset:8192
    v_mfma_f32_16x16x32_bf16 v[20:23], v[100:103], v[116:119], v[20:23]
    ds_read_b64_tr_b16 v[140:141], v183 offset:8192
    ds_read_b64_tr_b16 v[142:143], v183 offset:12288
    v_mfma_f32_16x16x32_bf16 v[24:27], v[104:107], v[116:119], v[24:27]
    ds_read_b128 v[156:159], v177 offset:8448
    v_mfma_f32_16x16x32_bf16 v[28:31], v[108:111], v[116:119], v[28:31]
    s_add_u32 s30, s30, 32768
    s_cmp_ge_u32 s30, 163840
    s_cselect_b32 s30, 0, s30
    s_cselect_b32 s31, -131072, s53
    v_mfma_f32_16x16x32_bf16 v[32:35], v[96:99], v[120:123], v[32:35]
    v_add_u32 v180, s31, v180
    v_add_u32 v181, s31, v181
    v_mfma_f32_16x16x32_bf16 v[36:39], v[100:103], v[120:123], v[36:39]
    v_add_u32 v182, s31, v182
    v_add_u32 v183, s31, v183
    v_mfma_f32_16x16x32_bf16 v[40:43], v[104:107], v[120:123], v[40:43]
    v_add_u32 v176, s31, v176
    v_add_u32 v177, s31, v177
    v_mfma_f32_16x16x32_bf16 v[44:47], v[108:111], v[120:123], v[44:47]
    v_mfma_f32_16x16x32_bf16 v[48:51], v[96:99], v[124:127], v[48:51]
    v_mfma_f32_16x16x32_bf16 v[52:55], v[100:103], v[124:127], v[52:55]
    s_waitcnt lgkmcnt(0)
    s_barrier
    v_mfma_f32_16x16x32_bf16 v[56:59], v[104:107], v[124:127], v[56:59]
    v_mfma_f32_16x16x32_bf16 v[60:63], v[108:111], v[124:127], v[60:63]
    v_mfma_f32_16x16x32_bf16 v[32:35], v[128:131], v[152:155], v[32:35]
    ds_read_b64_tr_b16 v[96:97], v180 offset:0
    ds_read_b64_tr_b16 v[98:99], v180 offset:4096
    v_mfma_f32_16x16x32_bf16 v[36:39], v[132:135], v[152:155], v[36:39]
    ds_read_b128 v[112:115], v178 offset:0
    v_mfma_f32_16x16x32_bf16 v[40:43], v[136:139], v[152:155], v[40:43]
    ds_read_b64_tr_b16 v[100:101], v181 offset:0
    ds_read_b64_tr_b16 v[102:103], v181 offset:4096
    v_mfma_f32_16x16x32_bf16 v[44:47], v[140:143], v[152:155], v[44:47]
    ds_read_b128 v[116:119], v178 offset:256
    v_mfma_f32_16x16x32_bf16 v[48:51], v[128:131], v[156:159], v[48:51]
    ds_read_b64_tr_b16 v[104:105], v182 offset:0
    ds_read_b64_tr_b16 v[106:107], v182 offset:4096
    v_mfma_f32_16x16x32_bf16 v[52:55], v[132:135], v[156:159], v[52:55]
    ds_read_b64_tr_b16 v[108:109], v183 offset:0
    ds_read_b64_tr_b16 v[110:111], v183 offset:4096
    v_mfma_f32_16x16x32_bf16 v[56:59], v[136:139], v[156:159], v[56:59]
    v_mfma_f32_16x16x32_bf16 v[60:63], v[140:143], v[156:159], v[60:63]
    v_mfma_f32_16x16x32_bf16 v[0:3], v[128:131], v[144:147], v[0:3]
    v_mfma_f32_16x16x32_bf16 v[4:7], v[132:135], v[144:147], v[4:7]
    v_mfma_f32_16x16x32_bf16 v[8:11], v[136:139], v[144:147], v[8:11]
    v_mfma_f32_16x16x32_bf16 v[12:15], v[140:143], v[144:147], v[12:15]
    v_mfma_f32_16x16x32_bf16 v[16:19], v[128:131], v[148:151], v[16:19]
    v_mfma_f32_16x16x32_bf16 v[20:23], v[132:135], v[148:151], v[20:23]
    v_mfma_f32_16x16x32_bf16 v[24:27], v[136:139], v[148:151], v[24:27]
    v_mfma_f32_16x16x32_bf16 v[28:31], v[140:143], v[148:151], v[28:31]
    s_waitcnt lgkmcnt(0)
    ds_read_b64_tr_b16 v[128:129], v180 offset:8192
    ds_read_b64_tr_b16 v[130:131], v180 offset:12288
    v_mfma_f32_16x16x32_bf16 v[64:67], v[96:99], v[112:115], v[64:67]
    ds_read_b128 v[144:147], v178 offset:4096
    buffer_store_dwordx4 v[32:35], v186, s[4:7], s44 offen offset:0 sc1
    v_mfma_f32_16x16x32_bf16 v[68:71], v[100:103], v[112:115], v[68:71]
    ds_read_b64_tr_b16 v[132:133], v181 offset:8192
    ds_read_b64_tr_b16 v[134:135], v181 offset:12288
    v_mfma_f32_16x16x32_bf16 v[72:75], v[104:107], v[112:115], v[72:75]
    ds_read_b128 v[148:151], v178 offset:4352
    buffer_store_dwordx4 v[36:39], v186, s[4:7], s44 offen offset:1024 sc1
    v_mfma_f32_16x16x32_bf16 v[76:79], v[108:111], v[112:115], v[76:79]
    ds_read_b64_tr_b16 v[136:137], v182 offset:8192
    ds_read_b64_tr_b16 v[138:139], v182 offset:12288
    v_mfma_f32_16x16x32_bf16 v[80:83], v[96:99], v[116:119], v[80:83]
    ds_read_b64_tr_b16 v[140:141], v183 offset:8192
    ds_read_b64_tr_b16 v[142:143], v183 offset:12288
    s_add_u32 s30, s30, 32768
    s_cmp_ge_u32 s30, 163840
    s_cselect_b32 s30, 0, s30
    s_cselect_b32 s31, -131072, s53
    buffer_store_dwordx4 v[40:43], v186, s[4:7], s44 offen offset:2048 sc1
    v_mfma_f32_16x16x32_bf16 v[84:87], v[100:103], v[116:119], v[84:87]
    v_add_u32 v180, s31, v180
    v_add_u32 v181, s31, v181
    v_add_u32 v182, s31, v182
    v_mfma_f32_16x16x32_bf16 v[88:91], v[104:107], v[116:119], v[88:91]
    v_add_u32 v183, s31, v183
    v_add_u32 v178, s31, v178
    buffer_store_dwordx4 v[44:47], v186, s[4:7], s44 offen offset:3072 sc1
    v_mfma_f32_16x16x32_bf16 v[92:95], v[108:111], v[116:119], v[92:95]
    s_waitcnt lgkmcnt(0)
    s_barrier
    v_mfma_f32_16x16x32_bf16 v[64:67], v[128:131], v[144:147], v[64:67]
    ds_read_b64_tr_b16 v[96:97], v180 offset:0
    ds_read_b64_tr_b16 v[98:99], v180 offset:4096
    v_mfma_f32_16x16x32_bf16 v[68:71], v[132:135], v[144:147], v[68:71]
    ds_read_b128 v[112:115], v178 offset:0
    buffer_store_dwordx4 v[48:51], v186, s[4:7], s45 offen offset:0 sc1
    v_mfma_f32_16x16x32_bf16 v[72:75], v[136:139], v[144:147], v[72:75]
    ds_read_b64_tr_b16 v[100:101], v181 offset:0
    ds_read_b64_tr_b16 v[102:103], v181 offset:4096
    v_mfma_f32_16x16x32_bf16 v[76:79], v[140:143], v[144:147], v[76:79]
    ds_read_b128 v[116:119], v178 offset:256
    buffer_store_dwordx4 v[52:55], v186, s[4:7], s45 offen offset:1024 sc1
    v_mfma_f32_16x16x32_bf16 v[80:83], v[128:131], v[148:151], v[80:83]
    ds_read_b64_tr_b16 v[104:105], v182 offset:0
    ds_read_b64_tr_b16 v[106:107], v182 offset:4096
    v_mfma_f32_16x16x32_bf16 v[84:87], v[132:135], v[148:151], v[84:87]
    ds_read_b64_tr_b16 v[108:109], v183 offset:0
    ds_read_b64_tr_b16 v[110:111], v183 offset:4096
    buffer_store_dwordx4 v[56:59], v186, s[4:7], s45 offen offset:2048 sc1
    v_mfma_f32_16x16x32_bf16 v[88:91], v[136:139], v[148:151], v[88:91]
    v_mfma_f32_16x16x32_bf16 v[92:95], v[140:143], v[148:151], v[92:95]
    buffer_store_dwordx4 v[60:63], v186, s[4:7], s45 offen offset:3072 sc1
    s_mov_b32 s32, 1
.Lk4_cs:
    s_bitcmp1_b32 s50, s32
    s_cbranch_scc1 .Lk4_side
.Lk4_back:
    s_waitcnt lgkmcnt(0)
    ds_read_b64_tr_b16 v[128:129], v180 offset:8192
    ds_read_b64_tr_b16 v[130:131], v180 offset:12288
    v_mfma_f32_16x16x32_bf16 v[64:67], v[96:99], v[112:115], v[64:67]
    ds_read_b128 v[144:147], v178 offset:4096
    v_mfma_f32_16x16x32_bf16 v[68:71], v[100:103], v[112:115], v[68:71]
    ds_read_b64_tr_b16 v[132:133], v181 offset:8192
    ds_read_b64_tr_b16 v[134:135], v181 offset:12288
    v_mfma_f32_16x16x32_bf16 v[72:75], v[104:107], v[112:115], v[72:75]
    ds_read_b128 v[148:151], v178 offset:4352
    v_mfma_f32_16x16x32_bf16 v[76:79], v[108:111], v[112:115], v[76:79]
    ds_read_b64_tr_b16 v[136:137], v182 offset:8192
    ds_read_b64_tr_b16 v[138:139], v182 offset:12288
    v_mfma_f32_16x16x32_bf16 v[80:83], v[96:99], v[116:119], v[80:83]
    ds_read_b64_tr_b16 v[140:141], v183 offset:8192
    ds_read_b64_tr_b16 v[142:143], v183 offset:12288
    s_add_u32 s30, s30, 32768
    s_cmp_ge_u32 s30, 163840
    s_cselect_b32 s30, 0, s30
    s_cselect_b32 s31, -131072, s53
    v_mfma_f32_16x16x32_bf16 v[84:87], v[100:103], v[116:119], v[84:87]
    v_add_u32 v180, s31, v180
    v_add_u32 v181, s31, v181
    v_add_u32 v182, s31, v182
    v_mfma_f32_16x16x32_bf16 v[88:91], v[104:107], v[116:119], v[88:91]
    v_add_u32 v183, s31, v183
    v_add_u32 v178, s31, v178
    v_mfma_f32_16x16x32_bf16 v[92:95], v[108:111], v[116:119], v[92:95]
    s_waitcnt lgkmcnt(0)
    s_barrier
    v_mfma_f32_16x16x32_bf16 v[64:67], v[128:131], v[144:147], v[64:67]
    ds_read_b64_tr_b16 v[96:97], v180 offset:0
    ds_read_b64_tr_b16 v[98:99], v180 offset:4096
    v_mfma_f32_16x16x32_bf16 v[68:71], v[132:135], v[144:147], v[68:71]
    ds_read_b128 v[112:115], v178 offset:0
    v_mfma_f32_16x16x32_bf16 v[72:75], v[136:139], v[144:147], v[72:75]
    ds_read_b64_tr_b16 v[100:101], v181 offset:0
    ds_read_b64_tr_b16 v[102:103], v181 offset:4096
    v_mfma_f32_16x16x32_bf16 v[76:79], v[140:143], v[144:147], v[76:79]
    ds_read_b128 v[116:119], v178 offset:256
    v_mfma_f32_16x16x32_bf16 v[80:83], v[128:131], v[148:151], v[80:83]
    ds_read_b64_tr_b16 v[104:105], v182 offset:0
    ds_read_b64_tr_b16 v[106:107], v182 offset:4096
    v_mfma_f32_16x16x32_bf16 v[84:87], v[132:135], v[148:151], v[84:87]
    ds_read_b64_tr_b16 v[108:109], v183 offset:0
    ds_read_b64_tr_b16 v[110:111], v183 offset:4096
    v_mfma_f32_16x16x32_bf16 v[88:91], v[136:139], v[148:151], v[88:91]
    s_add_u32 s32, s32, 1
    s_cmp_lg_u32 s32, 12
    v_mfma_f32_16x16x32_bf16 v[92:95], v[140:143], v[148:151], v[92:95]
    s_cbranch_scc1 .Lk4_cs
    s_waitcnt lgkmcnt(0)
    ds_read_b64_tr_b16 v[128:129], v180 offset:8192
    ds_read_b64_tr_b16 v[130:131], v180 offset:12288
    v_mfma_f32_16x16x32_bf16 v[64:67], v[96:99], v[112:115], v[64:67]
    ds_read_b128 v[144:147], v178 offset:4096
    s_waitcnt vmcnt(7)
    v_add_f32 v0, v0, v32
    v_add_f32 v1, v1, v33
    v_add_f32 v2, v2, v34
    v_mfma_f32_16x16x32_bf16 v[68:71], v[100:103], v[112:115], v[68:71]
    ds_read_b64_tr_b16 v[132:133], v181 offset:8192
    ds_read_b64_tr_b16 v[134:135], v181 offset:12288
    v_add_f32 v3, v3, v35
    v_mul_f32 v188, s51, v0
    v_mul_f32 v189, s51, v1
    v_mul_f32 v190, s51, v2
    v_mfma_f32_16x16x32_bf16 v[72:75], v[104:107], v[112:115], v[72:75]
    ds_read_b128 v[148:151], v178 offset:4352
    v_mul_f32 v191, s51, v3
    v_exp_f32 v188, v188
    v_exp_f32 v189, v189
    v_mfma_f32_16x16x32_bf16 v[76:79], v[108:111], v[112:115], v[76:79]
    ds_read_b64_tr_b16 v[136:137], v182 offset:8192
    ds_read_b64_tr_b16 v[138:139], v182 offset:12288
    v_exp_f32 v190, v190
    v_exp_f32 v191, v191
    v_lshlrev_b32 v32, 16, v160
    v_and_b32 v33, s52, v160
    v_mfma_f32_16x16x32_bf16 v[80:83], v[96:99], v[116:119], v[80:83]
    ds_read_b64_tr_b16 v[140:141], v183 offset:8192
    ds_read_b64_tr_b16 v[142:143], v183 offset:12288
    s_add_u32 s30, s30, 32768
    s_cmp_ge_u32 s30, 163840
    s_cselect_b32 s30, 0, s30
    s_cselect_b32 s31, -131072, s53
    v_add_f32 v188, 1.0, v188
    v_add_f32 v189, 1.0, v189
    v_add_f32 v190, 1.0, v190
    v_add_f32 v191, 1.0, v191
    v_mfma_f32_16x16x32_bf16 v[84:87], v[100:103], v[116:119], v[84:87]
    v_add_u32 v180, s31, v180
    v_add_u32 v181, s31, v181
    v_add_u32 v182, s31, v182
    v_rcp_f32 v188, v188
    v_rcp_f32 v189, v189
    v_rcp_f32 v190, v190
    v_mfma_f32_16x16x32_bf16 v[88:91], v[104:107], v[116:119], v[88:91]
    v_add_u32 v183, s31, v183
    v_add_u32 v178, s31, v178
    v_rcp_f32 v191, v191
    v_lshlrev_b32 v34, 16, v161
    v_and_b32 v35, s52, v161
    v_mul_f32 v0, v0, v188
    v_mfma_f32_16x16x32_bf16 v[92:95], v[108:111], v[116:119], v[92:95]
    v_mul_f32 v1, v1, v189
    v_mul_f32 v2, v2, v190
    v_mul_f32 v3, v3, v191
    s_waitcnt lgkmcnt(0)
    s_barrier
    v_mfma_f32_16x16x32_bf16 v[64:67], v[128:131], v[144:147], v[64:67]
    ds_read_b64_tr_b16 v[96:97], v180 offset:0
    ds_read_b64_tr_b16 v[98:99], v180 offset:4096
    s_waitcnt vmcnt(6)
    v_add_f32 v4, v4, v36
    v_add_f32 v5, v5, v37
    v_add_f32 v6, v6, v38
    v_mfma_f32_16x16x32_bf16 v[68:71], v[132:135], v[144:147], v[68:71]
    ds_read_b128 v[112:115], v178 offset:0
    v_add_f32 v7, v7, v39
    v_mul_f32 v188, s51, v4
    v_mul_f32 v189, s51, v5
    v_mul_f32 v190, s51, v6
    v_mfma_f32_16x16x32_bf16 v[72:75], v[136:139], v[144:147], v[72:75]
    ds_read_b64_tr_b16 v[100:101], v181 offset:0
    ds_read_b64_tr_b16 v[102:103], v181 offset:4096
    v_mul_f32 v191, s51, v7
    v_exp_f32 v188, v188
    v_exp_f32 v189, v189
    v_mfma_f32_16x16x32_bf16 v[76:79], v[140:143], v[144:147], v[76:79]
    ds_read_b128 v[116:119], v178 offset:256
    v_exp_f32 v190, v190
    v_exp_f32 v191, v191
    v_lshlrev_b32 v36, 16, v162
    v_and_b32 v37, s52, v162
    v_mfma_f32_16x16x32_bf16 v[80:83], v[128:131], v[148:151], v[80:83]
    ds_read_b64_tr_b16 v[104:105], v182 offset:0
    ds_read_b64_tr_b16 v[106:107], v182 offset:4096
    v_add_f32 v188, 1.0, v188
    v_add_f32 v189, 1.0, v189
    v_add_f32 v190, 1.0, v190
    v_add_f32 v191, 1.0, v191
    v_mfma_f32_16x16x32_bf16 v[84:87], v[132:135], v[148:151], v[84:87]
    ds_read_b64_tr_b16 v[108:109], v183 offset:0
    ds_read_b64_tr_b16 v[110:111], v183 offset:4096
    v_rcp_f32 v188, v188
    v_rcp_f32 v189, v189
    v_rcp_f32 v190, v190
    v_mfma_f32_16x16x32_bf16 v[88:91], v[136:139], v[148:151], v[88:91]
    v_rcp_f32 v191, v191
    v_lshlrev_b32 v38, 16, v163
    v_and_b32 v39, s52, v163
    v_mul_f32 v4, v4, v188
    v_mfma_f32_16x16x32_bf16 v[92:95], v[140:143], v[148:151], v[92:95]
    v_mul_f32 v5, v5, v189
    v_mul_f32 v6, v6, v190
    v_mul_f32 v7, v7, v191
    s_waitcnt lgkmcnt(0)
    ds_read_b64_tr_b16 v[128:129], v180 offset:8192
    ds_read_b64_tr_b16 v[130:131], v180 offset:12288
    v_mfma_f32_16x16x32_bf16 v[64:67], v[96:99], v[112:115], v[64:67]
    ds_read_b128 v[144:147], v178 offset:4096
    s_waitcnt vmcnt(5)
    v_add_f32 v8, v8, v40
    v_add_f32 v9, v9, v41
    v_add_f32 v10, v10, v42
    v_mfma_f32_16x16x32_bf16 v[68:71], v[100:103], v[112:115], v[68:71]
    ds_read_b64_tr_b16 v[132:133], v181 offset:8192
    ds_read_b64_tr_b16 v[134:135], v181 offset:12288
    v_add_f32 v11, v11, v43
    v_mul_f32 v188, s51, v8
    v_mul_f32 v189, s51, v9
    v_mul_f32 v190, s51, v10
    v_mfma_f32_16x16x32_bf16 v[72:75], v[104:107], v[112:115], v[72:75]
    ds_read_b128 v[148:151], v178 offset:4352
    v_mul_f32 v191, s51, v11
    v_exp_f32 v188, v188
    v_exp_f32 v189, v189
    v_mfma_f32_16x16x32_bf16 v[76:79], v[108:111], v[112:115], v[76:79]
    ds_read_b64_tr_b16 v[136:137], v182 offset:8192
    ds_read_b64_tr_b16 v[138:139], v182 offset:12288
    v_exp_f32 v190, v190
    v_exp_f32 v191, v191
    v_lshlrev_b32 v40, 16, v164
    v_and_b32 v41, s52, v164
    v_mfma_f32_16x16x32_bf16 v[80:83], v[96:99], v[116:119], v[80:83]
    ds_read_b64_tr_b16 v[140:141], v183 offset:8192
    ds_read_b64_tr_b16 v[142:143], v183 offset:12288
    s_add_u32 s30, s30, 32768
    s_cmp_ge_u32 s30, 163840
    s_cselect_b32 s30, 0, s30
    s_cselect_b32 s31, -131072, s53
    v_add_f32 v188, 1.0, v188
    v_add_f32 v189, 1.0, v189
    v_add_f32 v190, 1.0, v190
    v_add_f32 v191, 1.0, v191
    v_mfma_f32_16x16x32_bf16 v[84:87], v[100:103], v[116:119], v[84:87]
    v_add_u32 v180, s31, v180
    v_add_u32 v181, s31, v181
    v_add_u32 v182, s31, v182
    v_rcp_f32 v188, v188
    v_rcp_f32 v189, v189
    v_rcp_f32 v190, v190
    v_mfma_f32_16x16x32_bf16 v[88:91], v[104:107], v[116:119], v[88:91]
    v_add_u32 v183, s31, v183
    v_add_u32 v178, s31, v178
    v_rcp_f32 v191, v191
    v_lshlrev_b32 v42, 16, v165
    v_and_b32 v43, s52, v165
    v_mul_f32 v8, v8, v188
    v_mfma_f32_16x16x32_bf16 v[92:95], v[108:111], v[116:119], v[92:95]
    v_mul_f32 v9, v9, v189
    v_mul_f32 v10, v10, v190
    v_mul_f32 v11, v11, v191
    s_waitcnt lgkmcnt(0)
    s_barrier
    v_mfma_f32_16x16x32_bf16 v[64:67], v[128:131], v[144:147], v[64:67]
    ds_read_b64_tr_b16 v[96:97], v180 offset:0
    ds_read_b64_tr_b16 v[98:99], v180 offset:4096
    s_waitcnt vmcnt(4)
    v_add_f32 v12, v12, v44
    v_add_f32 v13, v13, v45
    v_add_f32 v14, v14, v46
    v_mfma_f32_16x16x32_bf16 v[68:71], v[132:135], v[144:147], v[68:71]
    ds_read_b128 v[112:115], v178 offset:0
    v_add_f32 v15, v15, v47
    v_mul_f32 v188, s51, v12
    v_mul_f32 v189, s51, v13
    v_mul_f32 v190, s51, v14
    v_mfma_f32_16x16x32_bf16 v[72:75], v[136:139], v[144:147], v[72:75]
    ds_read_b64_tr_b16 v[100:101], v181 offset:0
    ds_read_b64_tr_b16 v[102:103], v181 offset:4096
    v_mul_f32 v191, s51, v15
    v_exp_f32 v188, v188
    v_exp_f32 v189, v189
    v_mfma_f32_16x16x32_bf16 v[76:79], v[140:143], v[144:147], v[76:79]
    ds_read_b128 v[116:119], v178 offset:256
    v_exp_f32 v190, v190
    v_exp_f32 v191, v191
    v_lshlrev_b32 v44, 16, v166
    v_and_b32 v45, s52, v166
    v_mfma_f32_16x16x32_bf16 v[80:83], v[128:131], v[148:151], v[80:83]
    ds_read_b64_tr_b16 v[104:105], v182 offset:0
    ds_read_b64_tr_b16 v[106:107], v182 offset:4096
    v_add_f32 v188, 1.0, v188
    v_add_f32 v189, 1.0, v189
    v_add_f32 v190, 1.0, v190
    v_add_f32 v191, 1.0, v191
    v_mfma_f32_16x16x32_bf16 v[84:87], v[132:135], v[148:151], v[84:87]
    ds_read_b64_tr_b16 v[108:109], v183 offset:0
    ds_read_b64_tr_b16 v[110:111], v183 offset:4096
    v_rcp_f32 v188, v188
    v_rcp_f32 v189, v189
    v_rcp_f32 v190, v190
    v_mfma_f32_16x16x32_bf16 v[88:91], v[136:139], v[148:151], v[88:91]
    v_rcp_f32 v191, v191
    v_lshlrev_b32 v46, 16, v167
    v_and_b32 v47, s52, v167
    v_mul_f32 v12, v12, v188
    v_mfma_f32_16x16x32_bf16 v[92:95], v[140:143], v[148:151], v[92:95]
    v_mul_f32 v13, v13, v189
    v_mul_f32 v14, v14, v190
    v_mul_f32 v15, v15, v191
    s_waitcnt lgkmcnt(0)
    ds_read_b64_tr_b16 v[128:129], v180 offset:8192
    ds_read_b64_tr_b16 v[130:131], v180 offset:12288
    v_mfma_f32_16x16x32_bf16 v[64:67], v[96:99], v[112:115], v[64:67]
    ds_read_b128 v[144:147], v178 offset:4096
    s_waitcnt vmcnt(3)
    v_add_f32 v16, v16, v48
    v_add_f32 v17, v17, v49
    v_add_f32 v18, v18, v50
    v_mfma_f32_16x16x32_bf16 v[68:71], v[100:103], v[112:115], v[68:71]
    ds_read_b64_tr_b16 v[132:133], v181 offset:8192
    ds_read_b64_tr_b16 v[134:135], v181 offset:12288
    v_add_f32 v19, v19, v51
    v_mul_f32 v188, s51, v16
    v_mul_f32 v189, s51, v17
    v_mul_f32 v190, s51, v18
    v_mfma_f32_16x16x32_bf16 v[72:75], v[104:107], v[112:115], v[72:75]
    ds_read_b128 v[148:151], v178 offset:4352
    v_mul_f32 v191, s51, v19
    v_exp_f32 v188, v188
    v_exp_f32 v189, v189
    v_mfma_f32_16x16x32_bf16 v[76:79], v[108:111], v[112:115], v[76:79]
    ds_read_b64_tr_b16 v[136:137], v182 offset:8192
    ds_read_b64_tr_b16 v[138:139], v182 offset:12288
    v_exp_f32 v190, v190
    v_exp_f32 v191, v191
    v_lshlrev_b32 v48, 16, v168
    v_and_b32 v49, s52, v168
    v_mfma_f32_16x16x32_bf16 v[80:83], v[96:99], v[116:119], v[80:83]
    ds_read_b64_tr_b16 v[140:141], v183 offset:8192
    ds_read_b64_tr_b16 v[142:143], v183 offset:12288
    s_add_u32 s30, s30, 32768
    s_cmp_ge_u32 s30, 163840
    s_cselect_b32 s30, 0, s30
    s_cselect_b32 s31, -131072, s53
    v_add_f32 v188, 1.0, v188
    v_add_f32 v189, 1.0, v189
    v_add_f32 v190, 1.0, v190
    v_add_f32 v191, 1.0, v191
    v_mfma_f32_16x16x32_bf16 v[84:87], v[100:103], v[116:119], v[84:87]
    v_add_u32 v180, s31, v180
    v_add_u32 v181, s31, v181
    v_add_u32 v182, s31, v182
    v_rcp_f32 v188, v188
    v_rcp_f32 v189, v189
    v_rcp_f32 v190, v190
    v_mfma_f32_16x16x32_bf16 v[88:91], v[104:107], v[116:119], v[88:91]
    v_add_u32 v183, s31, v183
    v_add_u32 v178, s31, v178
    v_rcp_f32 v191, v191
    v_lshlrev_b32 v50, 16, v169
    v_and_b32 v51, s52, v169
    v_mul_f32 v16, v16, v188
    v_mfma_f32_16x16x32_bf16 v[92:95], v[108:111], v[116:119], v[92:95]
    v_mul_f32 v17, v17, v189
    v_mul_f32 v18, v18, v190
    v_mul_f32 v19, v19, v191
    s_waitcnt lgkmcnt(0)
    s_barrier
    v_mfma_f32_16x16x32_bf16 v[64:67], v[128:131], v[144:147], v[64:67]
    ds_read_b64_tr_b16 v[96:97], v180 offset:0
    ds_read_b64_tr_b16 v[98:99], v180 offset:4096
    s_waitcnt vmcnt(2)
    v_add_f32 v20, v20, v52
    v_add_f32 v21, v21, v53
    v_add_f32 v22, v22, v54
    v_mfma_f32_16x16x32_bf16 v[68:71], v[132:135], v[144:147], v[68:71]
    ds_read_b128 v[112:115], v178 offset:0
    v_add_f32 v23, v23, v55
    v_mul_f32 v188, s51, v20
    v_mul_f32 v189, s51, v21
    v_mul_f32 v190, s51, v22
    v_mfma_f32_16x16x32_bf16 v[72:75], v[136:139], v[144:147], v[72:75]
    ds_read_b64_tr_b16 v[100:101], v181 offset:0
    ds_read_b64_tr_b16 v[102:103], v181 offset:4096
    v_mul_f32 v191, s51, v23
    v_exp_f32 v188, v188
    v_exp_f32 v189, v189
    v_mfma_f32_16x16x32_bf16 v[76:79], v[140:143], v[144:147], v[76:79]
    ds_read_b128 v[116:119], v178 offset:256
    v_exp_f32 v190, v190
    v_exp_f32 v191, v191
    v_lshlrev_b32 v52, 16, v170
    v_and_b32 v53, s52, v170
    v_mfma_f32_16x16x32_bf16 v[80:83], v[128:131], v[148:151], v[80:83]
    ds_read_b64_tr_b16 v[104:105], v182 offset:0
    ds_read_b64_tr_b16 v[106:107], v182 offset:4096
    v_add_f32 v188, 1.0, v188
    v_add_f32 v189, 1.0, v189
    v_add_f32 v190, 1.0, v190
    v_add_f32 v191, 1.0, v191
    v_mfma_f32_16x16x32_bf16 v[84:87], v[132:135], v[148:151], v[84:87]
    ds_read_b64_tr_b16 v[108:109], v183 offset:0
    ds_read_b64_tr_b16 v[110:111], v183 offset:4096
    v_rcp_f32 v188, v188
    v_rcp_f32 v189, v189
    v_rcp_f32 v190, v190
    v_mfma_f32_16x16x32_bf16 v[88:91], v[136:139], v[148:151], v[88:91]
    v_rcp_f32 v191, v191
    v_lshlrev_b32 v54, 16, v171
    v_and_b32 v55, s52, v171
    v_mul_f32 v20, v20, v188
    v_mfma_f32_16x16x32_bf16 v[92:95], v[140:143], v[148:151], v[92:95]
    v_mul_f32 v21, v21, v189
    v_mul_f32 v22, v22, v190
    v_mul_f32 v23, v23, v191
    s_waitcnt lgkmcnt(0)
    ds_read_b64_tr_b16 v[128:129], v180 offset:8192
    ds_read_b64_tr_b16 v[130:131], v180 offset:12288
    v_mfma_f32_16x16x32_bf16 v[64:67], v[96:99], v[112:115], v[64:67]
    ds_read_b128 v[144:147], v178 offset:4096
    s_waitcnt vmcnt(1)
    v_add_f32 v24, v24, v56
    v_add_f32 v25, v25, v57
    v_add_f32 v26, v26, v58
    v_mfma_f32_16x16x32_bf16 v[68:71], v[100:103], v[112:115], v[68:71]
    ds_read_b64_tr_b16 v[132:133], v181 offset:8192
    ds_read_b64_tr_b16 v[134:135], v181 offset:12288
    v_add_f32 v27, v27, v59
    v_mul_f32 v188, s51, v24
    v_mul_f32 v189, s51, v25
    v_mul_f32 v190, s51, v26
    v_mfma_f32_16x16x32_bf16 v[72:75], v[104:107], v[112:115], v[72:75]
    ds_read_b128 v[148:151], v178 offset:4352
    v_mul_f32 v191, s51, v27
    v_exp_f32 v188, v188
    v_exp_f32 v189, v189
    v_mfma_f32_16x16x32_bf16 v[76:79], v[108:111], v[112:115], v[76:79]
    ds_read_b64_tr_b16 v[136:137], v182 offset:8192
    ds_read_b64_tr_b16 v[138:139], v182 offset:12288
    v_exp_f32 v190, v190
    v_exp_f32 v191, v191
    v_lshlrev_b32 v56, 16, v172
    v_and_b32 v57, s52, v172
    v_mfma_f32_16x16x32_bf16 v[80:83], v[96:99], v[116:119], v[80:83]
    ds_read_b64_tr_b16 v[140:141], v183 offset:8192
    ds_read_b64_tr_b16 v[142:143], v183 offset:12288
    v_add_f32 v188, 1.0, v188
    v_add_f32 v189, 1.0, v189
    v_add_f32 v190, 1.0, v190
    v_add_f32 v191, 1.0, v191
    v_mfma_f32_16x16x32_bf16 v[84:87], v[100:103], v[116:119], v[84:87]
    v_rcp_f32 v188, v188
    v_rcp_f32 v189, v189
    v_rcp_f32 v190, v190
    v_mfma_f32_16x16x32_bf16 v[88:91], v[104:107], v[116:119], v[88:91]
    v_rcp_f32 v191, v191
    v_lshlrev_b32 v58, 16, v173
    v_and_b32 v59, s52, v173
    v_mul_f32 v24, v24, v188
    v_mfma_f32_16x16x32_bf16 v[92:95], v[108:111], v[116:119], v[92:95]
    v_mul_f32 v25, v25, v189
    v_mul_f32 v26, v26, v190
    v_mul_f32 v27, v27, v191
    s_waitcnt lgkmcnt(0)
    v_mfma_f32_16x16x32_bf16 v[64:67], v[128:131], v[144:147], v[64:67]
    s_waitcnt vmcnt(0)
    v_add_f32 v28, v28, v60
    v_add_f32 v29, v29, v61
    v_add_f32 v30, v30, v62
    v_mfma_f32_16x16x32_bf16 v[68:71], v[132:135], v[144:147], v[68:71]
    v_add_f32 v31, v31, v63
    v_mul_f32 v188, s51, v28
    v_mul_f32 v189, s51, v29
    v_mul_f32 v190, s51, v30
    v_mfma_f32_16x16x32_bf16 v[72:75], v[136:139], v[144:147], v[72:75]
    v_mul_f32 v191, s51, v31
    v_exp_f32 v188, v188
    v_exp_f32 v189, v189
    v_mfma_f32_16x16x32_bf16 v[76:79], v[140:143], v[144:147], v[76:79]
    v_exp_f32 v190, v190
    v_exp_f32 v191, v191
    v_lshlrev_b32 v60, 16, v174
    v_and_b32 v61, s52, v174
    v_mfma_f32_16x16x32_bf16 v[80:83], v[128:131], v[148:151], v[80:83]
    v_add_f32 v188, 1.0, v188
    v_add_f32 v189, 1.0, v189
    v_add_f32 v190, 1.0, v190
    v_add_f32 v191, 1.0, v191
    v_mfma_f32_16x16x32_bf16 v[84:87], v[132:135], v[148:151], v[84:87]
    v_rcp_f32 v188, v188
    v_rcp_f32 v189, v189
    v_rcp_f32 v190, v190
    v_mfma_f32_16x16x32_bf16 v[88:91], v[136:139], v[148:151], v[88:91]
    v_rcp_f32 v191, v191
    v_lshlrev_b32 v62, 16, v175
    v_and_b32 v63, s52, v175
    v_mul_f32 v28, v28, v188
    v_mfma_f32_16x16x32_bf16 v[92:95], v[140:143], v[148:151], v[92:95]
    v_mul_f32 v29, v29, v189
    v_mul_f32 v30, v30, v190
    v_mul_f32 v31, v31, v191
    v_fma_f32 v32, v64, v0, v32
    v_fma_f32 v33, v65, v1, v33
    v_fma_f32 v34, v66, v2, v34
    v_fma_f32 v35, v67, v3, v35
    v_fma_f32 v36, v68, v4, v36
    v_fma_f32 v37, v69, v5, v37
    v_fma_f32 v38, v70, v6, v38
    v_fma_f32 v39, v71, v7, v39
    v_cvt_pk_bf16_f32 v96, v32, v33
    v_cvt_pk_bf16_f32 v97, v34, v35
    v_cvt_pk_bf16_f32 v98, v36, v37
    v_cvt_pk_bf16_f32 v99, v38, v39
    v_fma_f32 v40, v72, v8, v40
    v_fma_f32 v41, v73, v9, v41
    v_fma_f32 v42, v74, v10, v42
    v_fma_f32 v43, v75, v11, v43
    v_fma_f32 v44, v76, v12, v44
    v_fma_f32 v45, v77, v13, v45
    v_fma_f32 v46, v78, v14, v46
    v_fma_f32 v47, v79, v15, v47
    v_cvt_pk_bf16_f32 v100, v40, v41
    v_cvt_pk_bf16_f32 v101, v42, v43
    v_cvt_pk_bf16_f32 v102, v44, v45
    v_cvt_pk_bf16_f32 v103, v46, v47
    v_fma_f32 v48, v80, v16, v48
    v_fma_f32 v49, v81, v17, v49
    v_fma_f32 v50, v82, v18, v50
    v_fma_f32 v51, v83, v19, v51
    v_fma_f32 v52, v84, v20, v52
    v_fma_f32 v53, v85, v21, v53
    v_fma_f32 v54, v86, v22, v54
    v_fma_f32 v55, v87, v23, v55
    v_cvt_pk_bf16_f32 v104, v48, v49
    v_cvt_pk_bf16_f32 v105, v50, v51
    v_cvt_pk_bf16_f32 v106, v52, v53
    v_cvt_pk_bf16_f32 v107, v54, v55
    v_fma_f32 v56, v88, v24, v56
    v_fma_f32 v57, v89, v25, v57
    v_fma_f32 v58, v90, v26, v58
    v_fma_f32 v59, v91, v27, v59
    v_fma_f32 v60, v92, v28, v60
    v_fma_f32 v61, v93, v29, v61
    v_fma_f32 v62, v94, v30, v62
    v_fma_f32 v63, v95, v31, v63
    v_cvt_pk_bf16_f32 v108, v56, v57
    v_cvt_pk_bf16_f32 v109, v58, v59
    v_cvt_pk_bf16_f32 v110, v60, v61
    v_cvt_pk_bf16_f32 v111, v62, v63
    v_permlane16_swap_b32 v96, v98
    v_permlane16_swap_b32 v97, v99
    v_permlane16_swap_b32 v100, v102
    v_permlane16_swap_b32 v101, v103
    v_permlane16_swap_b32 v104, v106
    v_permlane16_swap_b32 v105, v107
    v_permlane16_swap_b32 v108, v110
    v_permlane16_swap_b32 v109, v111
    buffer_store_dwordx4 v[96:99], v185, s[16:19], 0 offen offset:0
    buffer_store_dwordx4 v[100:103], v185, s[16:19], 0 offen offset:64
    buffer_store_dwordx4 v[104:107], v185, s[16:19], s53 offen offset:0
    buffer_store_dwordx4 v[108:111], v185, s[16:19], s53 offen offset:64
    s_waitcnt vmcnt(0)
    s_branch .Lk4_end
.Lk4_side:
    s_cmp_eq_u32 s32, 6
    s_cbranch_scc1 .Lk4_poll
    s_cmp_eq_u32 s32, 9
    s_cbranch_scc1 .Lk4_chk
    v_mov_b32 v188, 1
    s_waitcnt vmcnt(0)
    s_mov_b64 exec, 1
    buffer_store_dword v188, v187, s[4:7], s48 offen sc1
    s_mov_b64 exec, -1
    v_permlane16_swap_b32 v160, v162
    v_permlane16_swap_b32 v161, v163
    v_permlane16_swap_b32 v164, v166
    v_permlane16_swap_b32 v165, v167
    v_permlane16_swap_b32 v168, v170
    v_permlane16_swap_b32 v169, v171
    v_permlane16_swap_b32 v172, v174
    v_permlane16_swap_b32 v173, v175
    s_branch .Lk4_back
.Lk4_poll:
    buffer_load_dword v192, v187, s[4:7], s49 offen sc1
    s_branch .Lk4_back
.Lk4_chk:
    s_mov_b32 s41, 200000
.Lk4_spin:
    s_waitcnt vmcnt(0)
    v_readfirstlane_b32 s40, v192
    s_sub_u32 s41, s41, 1
    s_cmp_lg_u32 s40, 0
    s_cbranch_scc1 .Lk4_got
    s_cmp_eq_u32 s41, 0
    s_cbranch_scc1 .Lk4_got
    buffer_load_dword v192, v187, s[4:7], s49 offen sc1
    s_branch .Lk4_spin
.Lk4_got:
    buffer_load_dwordx4 v[32:35], v186, s[4:7], s46 offen offset:0 sc1
    buffer_load_dwordx4 v[36:39], v186, s[4:7], s46 offen offset:1024 sc1
    buffer_load_dwordx4 v[40:43], v186, s[4:7], s46 offen offset:2048 sc1
    buffer_load_dwordx4 v[44:47], v186, s[4:7], s46 offen offset:3072 sc1
    buffer_load_dwordx4 v[48:51], v186, s[4:7], s47 offen offset:0 sc1
    buffer_load_dwordx4 v[52:55], v186, s[4:7], s47 offen offset:1024 sc1
    buffer_load_dwordx4 v[56:59], v186, s[4:7], s47 offen offset:2048 sc1
    buffer_load_dwordx4 v[60:63], v186, s[4:7], s47 offen offset:3072 sc1
    s_branch .Lk4_back
.Lk4_mside:
    s_cmp_eq_u32 s32, 5
    s_cbranch_scc1 .Lk4_mchk
    buffer_load_dword v192, v187, s[4:7], s38 offen offset:1024 sc1
    s_branch .Lk4_mback
.Lk4_mchk:
    s_mov_b32 s41, 200000
.Lk4_mspin:
    s_waitcnt vmcnt(0)
    v_readfirstlane_b32 s40, v192
    s_sub_u32 s41, s41, 1
    s_cmp_ge_u32 s40, 16
    s_cbranch_scc1 .Lk4_mback
    s_cmp_eq_u32 s41, 0
    s_cbranch_scc1 .Lk4_mback
    buffer_load_dword v192, v187, s[4:7], s38 offen offset:1024 sc1
    s_branch .Lk4_mspin
.Lk4_end:
s_endpgm
.section .rodata,"a"
.p2align 6
.amdhsa_kernel ln_kernel
  .amdhsa_next_free_vgpr 40
  .amdhsa_next_free_sgpr 48
  .amdhsa_accum_offset 40
  .amdhsa_group_segment_fixed_size 0
  .amdhsa_kernarg_size 96
  .amdhsa_user_sgpr_count 2
  .amdhsa_user_sgpr_kernarg_segment_ptr 1
  .amdhsa_system_sgpr_workgroup_id_x 1
.end_amdhsa_kernel
.p2align 6
.amdhsa_kernel mid_kernel
  .amdhsa_next_free_vgpr 256
  .amdhsa_next_free_sgpr 96
  .amdhsa_accum_offset 256
  .amdhsa_group_segment_fixed_size 0
  .amdhsa_kernarg_size 96
  .amdhsa_user_sgpr_count 2
  .amdhsa_user_sgpr_kernarg_segment_ptr 1
  .amdhsa_system_sgpr_workgroup_id_x 1
.end_amdhsa_kernel
```
